```python
import torch

def _softmax(x, axis=-1):
    return torch.softmax(x, dim=axis)
def _gelu(x):
    return torch.nn.functional.gelu(x, approximate="tanh")
def _silu(x):
    return torch.nn.functional.silu(x)
def _sigmoid(x):
    return torch.sigmoid(x)
def _layernorm(x, axis=-1, eps=1e-5):
    m = x.mean(dim=axis, keepdim=True)
    v = x.var(dim=axis, keepdim=True, unbiased=False)
    return (x - m) / torch.sqrt(v + eps)
def _scatter_add(tgt, idx, src, axis=0):
    return tgt.clone().index_add_(axis, idx, src)
def _segment_sum(src, seg, n):
    out = torch.zeros((n,) + src.shape[1:], dtype=src.dtype)
    return out.index_add_(0, seg, src)
def _pad(x, pw):
    flat = tuple(v for pair in reversed(pw) for v in pair)
    return torch.nn.functional.pad(x, flat)

kernel_name = 'sequential_preLN__ssm_conv_s4__glu_gated_reglu__prompt'

def setup_inputs():

    _w = (lambda a: (lambda t: t.to(torch.bfloat16) if t.is_floating_point() else t)(torch.as_tensor(a)))
    def _A_setup():
        B, L, D, N = 1, 2048, 640, 192
        A_re = -(lambda _x: torch.exp(torch.as_tensor(_x)))((lambda *s: torch.randn(*s, dtype=torch.bfloat16) * 3.2)(D, N))
        A_im = torch.pi * (lambda *s: torch.randn(*s, dtype=torch.bfloat16) * 0.05)(D, N)
        B_re = (lambda *s: torch.randn(*s, dtype=torch.bfloat16) * 0.05)(D, N)
        B_im = (lambda *s: torch.randn(*s, dtype=torch.bfloat16) * 0.1)(D, N)
        C_re = (lambda *s: torch.randn(*s, dtype=torch.bfloat16) * 0.1)(D, N)
        C_im = (lambda *s: torch.randn(*s, dtype=torch.bfloat16) * 0.05)(D, N)
        log_dt = (lambda *s: torch.randn(*s, dtype=torch.bfloat16) * 0.05)(D) * 0.5 - 4.0
        Dskip = (lambda *s: torch.randn(*s, dtype=torch.bfloat16) * 0.05)(D)
        return {
            "u": _w((lambda *s: torch.randn(*s, dtype=torch.bfloat16) * 0.05)(B, L, D)),
            "A_re": _w(A_re),
            "A_im": _w(A_im),
            "B_re": _w(B_re),
            "B_im": _w(B_im),
            "C_re": _w(C_re),
            "C_im": _w(C_im),
            "log_dt": _w(log_dt),
            "Dskip": _w(Dskip),
        }
    _A_in = _A_setup()

    def _B_setup():
        B, S, D, F = 1, 2048, 640, 1536
        return {
            "x": _w((lambda *s: torch.randn(*s, dtype=torch.bfloat16) * 0.05)(B, S, D)),
            "W_gate": _w((lambda *s: torch.randn(*s, dtype=torch.bfloat16) * 0.4)(D, F) * (2.0 / D) ** 0.5),
            "W_up": _w((lambda *s: torch.randn(*s, dtype=torch.bfloat16) * 0.4)(D, F) * (2.0 / D) ** 0.5),
            "W_down": _w((lambda *s: torch.randn(*s, dtype=torch.bfloat16) * 0.4)(F, D) * (1.0 / F) ** 0.5),
        }
    _B_in = _B_setup()

    return {
        "A_u": _A_in["u"],
        "A_A_re": _A_in["A_re"],
        "A_A_im": _A_in["A_im"],
        "A_B_re": _A_in["B_re"],
        "A_B_im": _A_in["B_im"],
        "A_C_re": _A_in["C_re"],
        "A_C_im": _A_in["C_im"],
        "A_log_dt": _A_in["log_dt"],
        "A_Dskip": _A_in["Dskip"],
        "B_x": _B_in["x"],
        "B_W_gate": _B_in["W_gate"],
        "B_W_up": _B_in["W_up"],
        "B_W_down": _B_in["W_down"],
    }

def reference(A_u, A_A_re, A_A_im, A_B_re, A_B_im, A_C_re, A_C_im, A_log_dt, A_Dskip, B_x, B_W_gate, B_W_up, B_W_down):
    def _A_ref(u, A_re, A_im, B_re, B_im, C_re, C_im, log_dt, Dskip):
        Bsz, L, D = u.shape
        dt = torch.exp(log_dt)[:, None]
        A = A_re + 1j * A_im
        Bc = B_re + 1j * B_im
        Cc = C_re + 1j * C_im
        logdA = dt * A
        dB = dt * Bc
        l = (lambda x, dt: x.to(dt))(torch.arange(L), A_re.dtype)
        P = torch.exp(logdA[:, :, None] * l[None, None, :])
        K = torch.einsum("dn,dnl,dn->dl", Cc, P, dB).real
        L2 = 2 * L
        Kp = _pad(K, ((0, 0), (0, L)))
        up = (lambda x, *d: x.permute(*d))(u, 0, 2, 1)
        up = _pad(up, ((0, 0), (0, 0), (0, L)))
        Kf = (lambda x, axes=(-2,-1): torch.fft.rfft2(x.float(), dim=axes))(Kp[:, None, :], axes=(-2, -1))
        Uf = (lambda x, axes=(-2,-1): torch.fft.rfft2(x.float(), dim=axes))(up[:, :, None, :], axes=(-2, -1))
        Yf = Uf * Kf[None, :, :, :]
        y = (lambda x, s, axes=(-2,-1): torch.fft.irfft2(x, s=s, dim=axes).to(torch.bfloat16))(Yf, (1, L2), axes=(-2, -1))[:, :, 0, :L]
        y = (lambda x, *d: x.permute(*d))(y, 0, 2, 1) + u * Dskip[None, None, :]
        return y

    def _B_ref(x, W_gate, W_up, W_down):
        gate = torch.einsum("bsd,df->bsf", x, W_gate)
        up = torch.einsum("bsd,df->bsf", x, W_up)
        gate = gate * (lambda x, dt: x.to(dt))(gate > 0, gate.dtype)
        h = gate * up
        return torch.einsum("bsf,fd->bsd", h, W_down)

    x = A_u
    h = x + _A_ref(_layernorm(x, axis=-1), A_A_re, A_A_im, A_B_re, A_B_im, A_C_re, A_C_im, A_log_dt, A_Dskip)
    h2 = h + _B_ref(_layernorm(h, axis=-1), B_W_gate, B_W_up, B_W_down)
    return h2
```

```asm
; @launch grid=(256,1,1) block=(256,1,1) lds=163840
.amdgcn_target "amdgcn-amd-amdhsa--gfx950"
.text
.globl sequential_preLN__ssm_conv_s4__glu_gated_reglu__prompt_kernel
.p2align 8
.type sequential_preLN__ssm_conv_s4__glu_gated_reglu__prompt_kernel,@function
sequential_preLN__ssm_conv_s4__glu_gated_reglu__prompt_kernel:
    s_cmp_ge_u32 s2, 256
    s_cbranch_scc1 END
    s_load_dwordx16 s[4:19], s[0:1], 0
    s_load_dwordx16 s[20:35], s[0:1], 64
    v_lshrrev_b32 v1, 6, v0
    v_and_b32 v240, 63, v0
    v_readfirstlane_b32 s3, v1
    v_lshlrev_b32 v241, 4, v240
    s_getpc_b64 s[70:71]
    s_lshr_b32 s72, s2, 3
    s_lshl_b32 s72, s72, 12
    v_lshlrev_b32 v1, 4, v0
    v_add_u32 v2, s72, v1
    v_min_u32 v2, 0x8b50, v2
    global_load_dwordx4 v[196:199], v2, s[70:71]
    s_lshr_b32 s57, s2, 1
    s_and_b32 s58, s2, 1
    s_mul_i32 s59, s57, 5
    s_mul_i32 s60, s58, 3
    s_add_u32 s60, s60, s59
    s_add_u32 s59, s59, 2
    s_and_b32 s61, s2, 1
    s_lshl_b32 s61, s61, 3
    s_bfe_u32 s72, s2, 0x30003
    s_add_u32 s61, s61, s72
    s_bfe_u32 s62, s2, 0x20001
    s_lshl_b32 s62, s62, 2
    s_lshr_b32 s72, s2, 6
    s_add_u32 s62, s62, s72
    s_mov_b32 s65, 0x3f803f80
    v_cmp_eq_u32_e64 vcc, 0, v240
    v_mov_b32 v242, 0x7ffffff0
    s_nop 0
    v_cndmask_b32 v242, v242, 0, vcc
    s_add_u32 s75, s3, 0
    s_mul_i32 s76, s75, 11
    s_lshr_b32 s76, s76, 5
    s_mul_i32 s77, s76, 3
    s_sub_u32 s77, s75, s77
    s_add_u32 s78, s60, s76
    s_sub_u32 s78, s78, 1
    s_cmp_eq_u32 s76, 0
    s_cselect_b32 s78, s59, s78
    s_min_u32 s78, s78, 639
    s_lshl_b32 s79, s78, 1
    v_mov_b32 v19, s79
    s_mul_i32 s78, s78, 384
    s_lshl_b32 s77, s77, 7
    s_add_u32 s78, s78, s77
    v_lshlrev_b32 v16, 1, v240
    v_add_u32 v16, s78, v16
    s_add_u32 s75, s3, 4
    s_mul_i32 s76, s75, 11
    s_lshr_b32 s76, s76, 5
    s_mul_i32 s77, s76, 3
    s_sub_u32 s77, s75, s77
    s_add_u32 s78, s60, s76
    s_sub_u32 s78, s78, 1
    s_cmp_eq_u32 s76, 0
    s_cselect_b32 s78, s59, s78
    s_min_u32 s78, s78, 639
    s_lshl_b32 s79, s78, 1
    v_mov_b32_e64 v20, s79
    s_mul_i32 s78, s78, 384
    s_lshl_b32 s77, s77, 7
    s_add_u32 s78, s78, s77
    v_lshlrev_b32 v17, 1, v240
    v_add_u32 v17, s78, v17
    s_add_u32 s75, s3, 8
    s_mul_i32 s76, s75, 11
    s_lshr_b32 s76, s76, 5
    s_mul_i32 s77, s76, 3
    s_sub_u32 s77, s75, s77
    s_add_u32 s78, s60, s76
    s_sub_u32 s78, s78, 1
    s_cmp_eq_u32 s76, 0
    s_cselect_b32 s78, s59, s78
    s_min_u32 s78, s78, 639
    s_lshl_b32 s79, s78, 1
    v_mov_b32_e64 v21, s79
    s_mul_i32 s78, s78, 384
    s_lshl_b32 s77, s77, 7
    s_add_u32 s78, s78, s77
    v_lshlrev_b32 v18, 1, v240
    v_add_u32 v18, s78, v18
    v_mov_b32 v200, 0
    v_mov_b32 v201, 0
    v_mov_b32 v202, 0
    v_mov_b32 v203, 0
    v_mov_b32 v204, 0
    v_mov_b32 v205, 0
    v_mov_b32 v206, 0
    v_mov_b32 v207, 0
    v_mov_b32 v208, 0
    v_mov_b32 v209, 0
    v_mov_b32 v210, 0
    v_mov_b32 v211, 0
    v_mov_b32 v212, 0
    v_mov_b32 v213, 0
    v_mov_b32 v214, 0
    v_mov_b32 v215, 0
    v_mov_b32 v216, 0
    v_mov_b32 v217, 0
    v_mov_b32 v218, 0
    v_mov_b32 v219, 0
    v_mov_b32 v220, 0
    v_mov_b32 v221, 0
    v_mov_b32 v222, 0
    v_mov_b32 v223, 0
    s_mul_i32 s75, s57, 5
    s_lshl_b32 s76, s58, 1
    s_add_u32 s75, s75, s76
    s_lshl_b32 s76, s75, 1
    s_and_b32 s76, s76, 0xfffc
    s_mul_i32 s72, s2, 10240
    s_sub_u32 s74, s3, 1
    s_lshl_b32 s74, s74, 10
    s_add_u32 s73, s72, s74
    s_add_u32 s74, s74, 88832
    v_bfe_u32 v27, v240, 5, 1
    v_cmp_eq_u32 vcc, s58, v27
    v_mov_b32 v246, 0x7ffffff0
    s_nop 0
    v_cndmask_b32 v246, v246, v1, vcc
    v_mov_b32 v40, -1
    v_mov_b32 v41, -1
    v_mov_b32 v42, -1
    v_mov_b32 v43, -1
    s_lshl_b32 s63, s59, 12
    s_add_u32 s63, s63, 0x500000
    s_lshl_b32 s64, s60, 12
    s_add_u32 s64, s64, 0x500000
    s_add_u32 s77, s64, 4096
    s_waitcnt lgkmcnt(0)
    s_nop 0
    global_load_short_d16_hi v200, v16, s[6:7]
    global_load_short_d16_hi v201, v16, s[8:9]
    global_load_short_d16_hi v202, v16, s[10:11]
    global_load_short_d16_hi v203, v16, s[12:13]
    global_load_short_d16_hi v204, v16, s[14:15]
    global_load_short_d16_hi v205, v16, s[16:17]
    global_load_short_d16_hi v206, v19, s[18:19]
    s_load_dword s56, s[34:35], 0
    s_load_dwordx2 s[78:79], s[20:21], s76
    s_mov_b32 s40, s4
    s_mov_b32 s41, s5
    s_mov_b32 s42, 0x280000
    s_mov_b32 s43, 0x20000
    s_mov_b32 s36, s34
    s_mov_b32 s37, s35
    s_mov_b32 s38, 0x1400000
    s_mov_b32 s39, 0x20000
    buffer_store_dwordx4 v[40:43], v246, s[36:39], s63 offen sc1
    buffer_store_dwordx4 v[40:43], v1, s[36:39], s64 offen sc1
    buffer_store_dwordx4 v[40:43], v1, s[36:39], s77 offen sc1
    s_mov_b32 s44, s24
    s_mov_b32 s45, s25
    s_mov_b32 s46, 0x1e0000
    s_mov_b32 s47, 0x20000
    s_mov_b32 s48, s26
    s_mov_b32 s49, s27
    s_mov_b32 s50, 0x1e0000
    s_mov_b32 s51, 0x20000
    s_mov_b32 s52, s30
    s_mov_b32 s53, s31
    s_mov_b32 s54, 0x280000
    s_mov_b32 s55, 0x20000
    s_mul_i32 s63, s3, 15232
    s_add_u32 s75, s63, 25600
    v_and_b32_e64 v36, 31, v240
    v_bfe_u32 v37, v240, 5, 1
    v_mul_u32_u24 v35, 272, v36
    v_lshl_add_u32 v35, v37, 4, v35
    v_add_u32_e64 v35, s75, v35
    s_mul_i32 s75, s3, 2816
    v_lshlrev_b32_e64 v8, 5, v36
    v_lshl_add_u32 v8, v37, 4, v8
    v_add_u32 v8, s75, v8
    v_lshlrev_b32 v9, 4, v36
    v_add_u32 v9, 1024, v9
    v_lshlrev_b32_e64 v10, 3, v36
    v_add_u32 v10, 1536, v10
    v_cmp_eq_u32 vcc, 1, v37
    v_mov_b32 v11, 8
    v_mov_b32 v24, 256
    v_cndmask_b32 v9, v9, v10, vcc
    v_cndmask_b32 v11, v11, v24, vcc
    v_add_u32 v9, s75, v9
    v_add_u32 v10, v9, v11
    v_mul_u32_u24 v11, 384, v37
    v_lshl_add_u32 v11, v36, 2, v11
    v_add_u32 v11, s75, v11
    v_lshrrev_b32 v24, 2, v240
    v_and_b32 v25, 3, v240
    v_lshrrev_b32 v26, 1, v24
    v_and_b32 v27, 1, v24
    v_mul_u32_u24 v28, 5, v26
    v_lshl_add_u32 v28, v27, 1, v28
    v_lshlrev_b32_e64 v28, 1, v28
    v_and_b32 v28, 0xfffc, v28
    v_mul_u32_u24 v29, 2560, v25
    s_and_b32 s76, s3, 1
    s_mul_i32 s75, s76, 640
    s_add_u32 s75, s75, 88832
    v_add3_u32 v225, v28, v29, s75
    v_add_u32 v226, 1280, v225
    v_and_b32 v26, 1, v26
    v_add_u32 v29, v26, v27
    v_lshlrev_b32 v30, 1, v27
    v_sub_u32 v30, v26, v30
    v_add_u32 v30, 2, v30
    v_lshl_add_u32 v30, v29, 16, v30
    s_mov_b32 s75, 0x0202
    v_mul_lo_u32 v30, v30, s75
    v_add_u32 v227, 0x01000100, v30
    v_add_u32_e64 v29, 1, v29
    s_mov_b32 s75, 0x02020202
    v_mul_lo_u32 v29, v29, s75
    v_add_u32 v228, 0x01000100, v29
    v_lshlrev_b32_e64 v24, 14, v24
    v_lshl_add_u32 v224, v25, 4, v24
    v_lshrrev_b32_e64 v24, 3, v240
    v_mul_u32_u24 v24, 1280, v24
    v_and_b32_e64 v25, 7, v240
    v_lshl_add_u32 v24, v25, 4, v24
    v_add_u32 v229, 88832, v24
    s_cmp_eq_u32 s3, 0
    s_cbranch_scc1 LD0
    s_add_u32 m0, s74, 0
    s_add_u32 s75, s73, 0
    buffer_load_dwordx4 v241, s[40:43], s75 offen lds
    s_add_u32 m0, s74, 3072
    s_add_u32 s75, s73, 3072
    buffer_load_dwordx4 v241, s[40:43], s75 offen lds
    s_add_u32 m0, s74, 6144
    s_add_u32 s75, s73, 6144
    buffer_load_dwordx4 v241, s[40:43], s75 offen lds
    s_add_u32 m0, s74, 9216
    s_add_u32 s75, s73, 9216
    s_cmp_eq_u32 s3, 1
    s_cselect_b32 s75, s75, 0x7ffffff0
    buffer_load_dwordx4 v241, s[40:43], s75 offen lds
    s_branch LDC
LD0:
    global_load_short_d16_hi v216, v18, s[6:7]
    global_load_short_d16_hi v217, v18, s[8:9]
    global_load_short_d16_hi v218, v18, s[10:11]
    global_load_short_d16_hi v219, v18, s[12:13]
    global_load_short_d16_hi v220, v18, s[14:15]
    global_load_short_d16_hi v221, v18, s[16:17]
    global_load_short_d16_hi v222, v21, s[18:19]
LDC:
    global_load_short_d16_hi v208, v17, s[6:7]
    global_load_short_d16_hi v209, v17, s[8:9]
    global_load_short_d16_hi v210, v17, s[10:11]
    global_load_short_d16_hi v211, v17, s[12:13]
    global_load_short_d16_hi v212, v17, s[14:15]
    global_load_short_d16_hi v213, v17, s[16:17]
    global_load_short_d16_hi v214, v20, s[18:19]
    s_mov_b32 s40, s28
    s_mov_b32 s41, s29
    s_mov_b32 s42, 0x1e0000
    s_mov_b32 s43, 0x20000
    s_mul_i32 s72, s2, 171
    s_lshr_b32 s72, s72, 11
    s_mul_i32 s77, s72, 12
    s_sub_u32 s77, s2, s77
    s_lshl_b32 s77, s77, 2
    s_add_u32 s77, s77, s3
    s_mul_i32 s64, s3, 5888
    s_add_u32 s64, s64, 140288
    v_lshrrev_b32 v30, 2, v240
    v_mul_u32_u24 v31, 5, v30
    v_add_u32 v31, 2, v31
    v_lshrrev_b32 v32, 1, v30
    v_mul_u32_u24 v32, 5, v32
    v_and_b32 v33, 1, v30
    v_mul_u32_u24 v33, 3, v33
    v_add_u32 v32, v32, v33
    s_cmp_lt_u32 s72, 4
    s_cselect_b64 vcc, -1, 0
    s_cselect_b32 s71, 80, 40
    v_cndmask_b32 v31, v32, v31, vcc
    v_mul_u32_u24 v31, 3072, v31
    v_and_b32 v32, 3, v240
    v_lshrrev_b32 v33, 5, v240
    v_xor_b32_e64 v32, v32, v33
    v_lshl_add_u32 v250, v32, 4, v31
    v_xor_b32_e64 v251, 32, v250
    s_mul_i32 s71, s71, 3072
    s_mul_i32 s75, s72, 160
    s_sub_u32 s70, s72, 4
    s_and_b32 s70, s70, 7
    s_mul_i32 s70, s70, 80
    s_cmp_ge_u32 s72, 12
    s_addc_u32 s70, s70, 0
    s_cmp_lt_u32 s72, 4
    s_cselect_b32 s75, s75, s70
    s_mul_i32 s75, s75, 3072
    s_lshl_b32 s70, s77, 6
    s_add_u32 s70, s75, s70
    s_add_u32 s71, s71, s70
    s_mov_b32 s4, s70
    s_mov_b32 s5, s71
    s_mul_i32 s72, s72, 48
    s_add_u32 s72, s72, s77
    v_and_b32 v24, 1, v240
    v_lshrrev_b32 v26, 4, v240
    s_lshl_b32 s20, s2, 14
    s_add_u32 s20, s20, 0x100000
    s_lshl_b32 s10, s59, 12
    s_add_u32 s10, s10, 0x500000
    s_lshl_b32 s11, s60, 12
    s_add_u32 s11, s11, 0x500000
    s_add_u32 s12, s11, 4096
    v_bfe_u32 v25, v240, 2, 2
    v_lshl_add_u32 v27, v26, 3, v25
    v_lshlrev_b32_e64 v27, 7, v27
    v_bfe_u32 v29, v240, 1, 1
    v_lshrrev_b32_e64 v27, 1, v27
    v_lshl_add_u32 v27, v29, 11, v27
    v_lshl_add_u32 v27, v24, 3, v27
    v_and_b32_e64 v28, 1, v26
    v_lshl_add_u32 v28, v29, 1, v28
    v_lshl_add_u32 v27, v28, 4, v27
    v_add_u32 v230, s64, v27
    v_xor_b32 v231, 16, v230
    v_xor_b32 v232, 32, v230
    v_xor_b32 v233, 48, v230
    v_bfe_u32 v25, v240, 1, 2
    v_lshlrev_b32_e64 v25, 2, v25
    v_bfe_u32 v27, v240, 3, 1
    v_lshl_add_u32 v27, v27, 1, v24
    v_add_u32_e64 v25, v25, v27
    v_lshl_add_u32 v25, v26, 4, v25
    v_lshlrev_b32 v234, 4, v25
    v_and_b32 v25, 15, v240
    v_cmp_gt_u32 vcc, 4, v25
    v_lshlrev_b32 v27, 6, v25
    v_and_b32_e64 v28, 1, v26
    v_lshl_add_u32 v27, v28, 5, v27
    v_lshrrev_b32_e64 v28, 1, v26
    v_lshl_add_u32 v27, v28, 3, v27
    v_mov_b32 v28, 0x7ffffff0
    v_cndmask_b32 v235, v28, v27, vcc
    s_lshl_b32 s6, s72, 12
    s_add_u32 s6, s6, 0x800000
    s_lshl_b32 s7, s72, 8
    s_add_u32 s7, s7, 0xc0000
    s_lshl_b32 s8, s72, 6
    s_add_u32 s8, s8, 0x70000
    s_cmp_lt_u32 s2, 240
    s_cselect_b32 s6, s6, 0x7ffffff0
    s_cselect_b32 s7, s7, 0x7ffffff0
    s_cselect_b32 s8, s8, 0x7ffffff0
    s_waitcnt lgkmcnt(0)
    s_mul_i32 s56, s56, 0x9E3779B1
    s_add_u32 s56, s56, 0x7F4A7C15
    v_mov_b32 v243, s56
    s_and_b32 s74, s57, 1
    s_lshl_b32 s73, s58, 1
    s_sub_u32 s73, s74, s73
    s_add_u32 s73, s73, 2
    s_lshl_b32 s73, s73, 4
    s_lshr_b64 s[22:23], s[78:79], s73
    s_lshl_b32 s22, s22, 16
    s_mov_b32 s23, s22
    s_add_u32 s73, s74, s58
    s_lshl_b32 s73, s73, 4
    s_lshr_b64 s[66:67], s[78:79], s73
    s_lshl_b32 s66, s66, 16
    s_mov_b32 s67, s66
    s_add_u32 s73, s74, s58
    s_add_u32 s73, s73, 1
    s_lshl_b32 s73, s73, 4
    s_lshr_b64 s[68:69], s[78:79], s73
    s_lshl_b32 s68, s68, 16
    s_mov_b32 s69, s68
    s_mov_b32 s76, 0x3fb8aa3b
    s_mov_b32 s77, 0x3e22f983
    s_mov_b32 m0, s63
    s_mov_b32 s75, s3
    s_waitcnt vmcnt(17)
    s_cmp_eq_u32 s3, 0
    s_cbranch_scc1 P0W
    s_waitcnt vmcnt(14)
P0W:
KGEN:
    v_mul_f32 v32, 0x3fb8aa3b, v206
    v_exp_f32 v32, v32
    s_nop 0
    v_cvt_pk_bf16_f32 v32, v32, v32
    v_lshlrev_b32_e64 v32, 16, v32
    v_pk_mul_f32 v[24:25], v[200:201], v[32:33] op_sel:[0,0] op_sel_hi:[1,0]
    v_pk_mul_f32 v[26:27], v[202:203], v[32:33] op_sel:[0,0] op_sel_hi:[1,0]
    v_pk_mul_f32 v[24:25], v[24:25], s[76:77]
    v_pk_mul_f32 v[104:105], v[204:205], v[26:27] op_sel:[0,0] op_sel_hi:[0,1]
    v_pk_fma_f32 v[104:105], v[204:205], v[26:27], v[104:105] op_sel:[1,1,0] op_sel_hi:[1,0,1] neg_lo:[1,0,0]
    v_mul_f32 v96, 0x41000000, v24
    v_mul_f32 v97, 0x41000000, v25
    v_fract_f32 v97, v97
    v_fract_f32 v99, v25
    v_mul_f32 v100, 0x43800000, v24
    v_mul_f32 v101, 0x43800000, v25
    v_fract_f32 v101, v101
    v_exp_f32 v96, v96
    v_cos_f32 v42, v97
    v_sin_f32 v43, v97
    v_exp_f32 v98, v24
    v_cos_f32 v88, v99
    v_sin_f32 v89, v99
    v_exp_f32 v100, v100
    v_cos_f32 v90, v101
    v_sin_f32 v91, v101
    v_pk_mul_f32 v[42:43], v[42:43], v[96:97] op_sel:[0,0] op_sel_hi:[1,0]
    v_pk_mul_f32 v[88:89], v[88:89], v[98:99] op_sel:[0,0] op_sel_hi:[1,0]
    v_pk_mul_f32 v[90:91], v[90:91], v[100:101] op_sel:[0,0] op_sel_hi:[1,0]
    v_pk_mul_f32 v[44:45], v[42:43], v[42:43] op_sel:[0,0] op_sel_hi:[0,1]
    v_pk_mul_f32 v[96:97], v[88:89], v[88:89] op_sel:[0,0] op_sel_hi:[0,1]
    v_pk_mul_f32 v[100:101], v[90:91], v[90:91] op_sel:[0,0] op_sel_hi:[0,1]
    v_pk_mul_f32 v[106:107], v[104:105], v[88:89] op_sel:[0,0] op_sel_hi:[0,1]
    v_pk_fma_f32 v[44:45], v[42:43], v[42:43], v[44:45] op_sel:[1,1,0] op_sel_hi:[1,0,1] neg_lo:[1,0,0]
    v_pk_fma_f32 v[96:97], v[88:89], v[88:89], v[96:97] op_sel:[1,1,0] op_sel_hi:[1,0,1] neg_lo:[1,0,0]
    v_pk_fma_f32 v[100:101], v[90:91], v[90:91], v[100:101] op_sel:[1,1,0] op_sel_hi:[1,0,1] neg_lo:[1,0,0]
    v_pk_fma_f32 v[106:107], v[104:105], v[88:89], v[106:107] op_sel:[1,1,0] op_sel_hi:[1,0,1] neg_lo:[1,0,0]
    v_pk_mul_f32 v[46:47], v[44:45], v[42:43] op_sel:[0,0] op_sel_hi:[0,1]
    v_pk_mul_f32 v[48:49], v[44:45], v[44:45] op_sel:[0,0] op_sel_hi:[0,1]
    v_pk_mul_f32 v[98:99], v[96:97], v[96:97] op_sel:[0,0] op_sel_hi:[0,1]
    v_pk_mul_f32 v[108:109], v[104:105], v[96:97] op_sel:[0,0] op_sel_hi:[0,1]
    v_pk_mul_f32 v[110:111], v[106:107], v[96:97] op_sel:[0,0] op_sel_hi:[0,1]
    v_pk_fma_f32 v[46:47], v[44:45], v[42:43], v[46:47] op_sel:[1,1,0] op_sel_hi:[1,0,1] neg_lo:[1,0,0]
    v_pk_fma_f32 v[48:49], v[44:45], v[44:45], v[48:49] op_sel:[1,1,0] op_sel_hi:[1,0,1] neg_lo:[1,0,0]
    v_pk_fma_f32 v[98:99], v[96:97], v[96:97], v[98:99] op_sel:[1,1,0] op_sel_hi:[1,0,1] neg_lo:[1,0,0]
    v_pk_fma_f32 v[108:109], v[104:105], v[96:97], v[108:109] op_sel:[1,1,0] op_sel_hi:[1,0,1] neg_lo:[1,0,0]
    v_pk_fma_f32 v[110:111], v[106:107], v[96:97], v[110:111] op_sel:[1,1,0] op_sel_hi:[1,0,1] neg_lo:[1,0,0]
    v_pk_mul_f32 v[50:51], v[48:49], v[42:43] op_sel:[0,0] op_sel_hi:[0,1]
    v_pk_mul_f32 v[52:53], v[48:49], v[44:45] op_sel:[0,0] op_sel_hi:[0,1]
    v_pk_mul_f32 v[54:55], v[48:49], v[46:47] op_sel:[0,0] op_sel_hi:[0,1]
    v_pk_mul_f32 v[56:57], v[48:49], v[48:49] op_sel:[0,0] op_sel_hi:[0,1]
    v_pk_fma_f32 v[50:51], v[48:49], v[42:43], v[50:51] op_sel:[1,1,0] op_sel_hi:[1,0,1] neg_lo:[1,0,0]
    v_pk_fma_f32 v[52:53], v[48:49], v[44:45], v[52:53] op_sel:[1,1,0] op_sel_hi:[1,0,1] neg_lo:[1,0,0]
    v_pk_fma_f32 v[54:55], v[48:49], v[46:47], v[54:55] op_sel:[1,1,0] op_sel_hi:[1,0,1] neg_lo:[1,0,0]
    v_pk_fma_f32 v[56:57], v[48:49], v[48:49], v[56:57] op_sel:[1,1,0] op_sel_hi:[1,0,1] neg_lo:[1,0,0]
    v_pk_mov_b32 v[92:93], v[56:57], v[56:57] op_sel:[0,1]
    v_pk_mul_f32 v[58:59], v[42:43], v[92:93] op_sel:[0,0] op_sel_hi:[0,1]
    v_pk_mul_f32 v[60:61], v[44:45], v[92:93] op_sel:[0,0] op_sel_hi:[0,1]
    v_pk_mul_f32 v[62:63], v[46:47], v[92:93] op_sel:[0,0] op_sel_hi:[0,1]
    v_pk_mul_f32 v[64:65], v[48:49], v[92:93] op_sel:[0,0] op_sel_hi:[0,1]
    v_pk_mul_f32 v[66:67], v[50:51], v[92:93] op_sel:[0,0] op_sel_hi:[0,1]
    v_pk_mul_f32 v[68:69], v[52:53], v[92:93] op_sel:[0,0] op_sel_hi:[0,1]
    v_pk_mul_f32 v[70:71], v[54:55], v[92:93] op_sel:[0,0] op_sel_hi:[0,1]
    v_pk_fma_f32 v[58:59], v[42:43], v[92:93], v[58:59] op_sel:[1,1,0] op_sel_hi:[1,0,1] neg_lo:[1,0,0]
    v_pk_fma_f32 v[60:61], v[44:45], v[92:93], v[60:61] op_sel:[1,1,0] op_sel_hi:[1,0,1] neg_lo:[1,0,0]
    v_pk_fma_f32 v[62:63], v[46:47], v[92:93], v[62:63] op_sel:[1,1,0] op_sel_hi:[1,0,1] neg_lo:[1,0,0]
    v_pk_fma_f32 v[64:65], v[48:49], v[92:93], v[64:65] op_sel:[1,1,0] op_sel_hi:[1,0,1] neg_lo:[1,0,0]
    v_pk_fma_f32 v[66:67], v[50:51], v[92:93], v[66:67] op_sel:[1,1,0] op_sel_hi:[1,0,1] neg_lo:[1,0,0]
    v_pk_fma_f32 v[68:69], v[52:53], v[92:93], v[68:69] op_sel:[1,1,0] op_sel_hi:[1,0,1] neg_lo:[1,0,0]
    v_pk_fma_f32 v[70:71], v[54:55], v[92:93], v[70:71] op_sel:[1,1,0] op_sel_hi:[1,0,1] neg_lo:[1,0,0]
    v_mov_b32 v72, 0x3f80
    v_cvt_pk_bf16_f32 v73, v42, v43
    v_cvt_pk_bf16_f32 v74, v44, v45
    v_cvt_pk_bf16_f32 v75, v46, v47
    v_cvt_pk_bf16_f32 v76, v48, v49
    v_cvt_pk_bf16_f32 v77, v50, v51
    v_cvt_pk_bf16_f32 v78, v52, v53
    v_cvt_pk_bf16_f32 v79, v54, v55
    v_cvt_pk_bf16_f32 v80, v56, v57
    v_cvt_pk_bf16_f32 v81, v58, v59
    v_cvt_pk_bf16_f32 v82, v60, v61
    v_cvt_pk_bf16_f32 v83, v62, v63
    v_cvt_pk_bf16_f32 v84, v64, v65
    v_cvt_pk_bf16_f32 v85, v66, v67
    v_cvt_pk_bf16_f32 v86, v68, v69
    v_cvt_pk_bf16_f32 v87, v70, v71
    ds_write_addtid_b32 v72 offset:25600
    ds_write_addtid_b32 v73 offset:25872
    ds_write_addtid_b32 v74 offset:26144
    ds_write_addtid_b32 v75 offset:26416
    ds_write_addtid_b32 v76 offset:26688
    ds_write_addtid_b32 v77 offset:26960
    ds_write_addtid_b32 v78 offset:27232
    ds_write_addtid_b32 v79 offset:27504
    ds_write_addtid_b32 v80 offset:27776
    ds_write_addtid_b32 v81 offset:28048
    ds_write_addtid_b32 v82 offset:28320
    ds_write_addtid_b32 v83 offset:28592
    ds_write_addtid_b32 v84 offset:28864
    ds_write_addtid_b32 v85 offset:29136
    ds_write_addtid_b32 v86 offset:29408
    ds_write_addtid_b32 v87 offset:29680
    v_pk_mul_f32 v[40:41], v[56:57], v[92:93] op_sel:[0,0] op_sel_hi:[0,1]
    v_pk_mul_f32 v[42:43], v[58:59], v[92:93] op_sel:[0,0] op_sel_hi:[0,1]
    v_pk_mul_f32 v[44:45], v[60:61], v[92:93] op_sel:[0,0] op_sel_hi:[0,1]
    v_pk_mul_f32 v[46:47], v[62:63], v[92:93] op_sel:[0,0] op_sel_hi:[0,1]
    v_pk_mul_f32 v[48:49], v[64:65], v[92:93] op_sel:[0,0] op_sel_hi:[0,1]
    v_pk_mul_f32 v[50:51], v[66:67], v[92:93] op_sel:[0,0] op_sel_hi:[0,1]
    v_pk_mul_f32 v[52:53], v[68:69], v[92:93] op_sel:[0,0] op_sel_hi:[0,1]
    v_pk_mul_f32 v[54:55], v[70:71], v[92:93] op_sel:[0,0] op_sel_hi:[0,1]
    v_pk_fma_f32 v[40:41], v[56:57], v[92:93], v[40:41] op_sel:[1,1,0] op_sel_hi:[1,0,1] neg_lo:[1,0,0]
    v_pk_fma_f32 v[42:43], v[58:59], v[92:93], v[42:43] op_sel:[1,1,0] op_sel_hi:[1,0,1] neg_lo:[1,0,0]
    v_pk_fma_f32 v[44:45], v[60:61], v[92:93], v[44:45] op_sel:[1,1,0] op_sel_hi:[1,0,1] neg_lo:[1,0,0]
    v_pk_fma_f32 v[46:47], v[62:63], v[92:93], v[46:47] op_sel:[1,1,0] op_sel_hi:[1,0,1] neg_lo:[1,0,0]
    v_pk_fma_f32 v[48:49], v[64:65], v[92:93], v[48:49] op_sel:[1,1,0] op_sel_hi:[1,0,1] neg_lo:[1,0,0]
    v_pk_fma_f32 v[50:51], v[66:67], v[92:93], v[50:51] op_sel:[1,1,0] op_sel_hi:[1,0,1] neg_lo:[1,0,0]
    v_pk_fma_f32 v[52:53], v[68:69], v[92:93], v[52:53] op_sel:[1,1,0] op_sel_hi:[1,0,1] neg_lo:[1,0,0]
    v_pk_fma_f32 v[54:55], v[70:71], v[92:93], v[54:55] op_sel:[1,1,0] op_sel_hi:[1,0,1] neg_lo:[1,0,0]
    v_pk_mul_f32 v[56:57], v[40:41], v[92:93] op_sel:[0,0] op_sel_hi:[0,1]
    v_pk_mul_f32 v[58:59], v[42:43], v[92:93] op_sel:[0,0] op_sel_hi:[0,1]
    v_pk_mul_f32 v[60:61], v[44:45], v[92:93] op_sel:[0,0] op_sel_hi:[0,1]
    v_pk_mul_f32 v[62:63], v[46:47], v[92:93] op_sel:[0,0] op_sel_hi:[0,1]
    v_pk_mul_f32 v[64:65], v[48:49], v[92:93] op_sel:[0,0] op_sel_hi:[0,1]
    v_pk_mul_f32 v[66:67], v[50:51], v[92:93] op_sel:[0,0] op_sel_hi:[0,1]
    v_pk_mul_f32 v[68:69], v[52:53], v[92:93] op_sel:[0,0] op_sel_hi:[0,1]
    v_pk_mul_f32 v[70:71], v[54:55], v[92:93] op_sel:[0,0] op_sel_hi:[0,1]
    v_pk_fma_f32 v[56:57], v[40:41], v[92:93], v[56:57] op_sel:[1,1,0] op_sel_hi:[1,0,1] neg_lo:[1,0,0]
    v_pk_fma_f32 v[58:59], v[42:43], v[92:93], v[58:59] op_sel:[1,1,0] op_sel_hi:[1,0,1] neg_lo:[1,0,0]
    v_pk_fma_f32 v[60:61], v[44:45], v[92:93], v[60:61] op_sel:[1,1,0] op_sel_hi:[1,0,1] neg_lo:[1,0,0]
    v_pk_fma_f32 v[62:63], v[46:47], v[92:93], v[62:63] op_sel:[1,1,0] op_sel_hi:[1,0,1] neg_lo:[1,0,0]
    v_pk_fma_f32 v[64:65], v[48:49], v[92:93], v[64:65] op_sel:[1,1,0] op_sel_hi:[1,0,1] neg_lo:[1,0,0]
    v_pk_fma_f32 v[66:67], v[50:51], v[92:93], v[66:67] op_sel:[1,1,0] op_sel_hi:[1,0,1] neg_lo:[1,0,0]
    v_pk_fma_f32 v[68:69], v[52:53], v[92:93], v[68:69] op_sel:[1,1,0] op_sel_hi:[1,0,1] neg_lo:[1,0,0]
    v_pk_fma_f32 v[70:71], v[54:55], v[92:93], v[70:71] op_sel:[1,1,0] op_sel_hi:[1,0,1] neg_lo:[1,0,0]
    v_cvt_pk_bf16_f32 v72, v40, v41
    v_cvt_pk_bf16_f32 v73, v42, v43
    v_cvt_pk_bf16_f32 v74, v44, v45
    v_cvt_pk_bf16_f32 v75, v46, v47
    v_cvt_pk_bf16_f32 v76, v48, v49
    v_cvt_pk_bf16_f32 v77, v50, v51
    v_cvt_pk_bf16_f32 v78, v52, v53
    v_cvt_pk_bf16_f32 v79, v54, v55
    v_cvt_pk_bf16_f32 v80, v56, v57
    v_cvt_pk_bf16_f32 v81, v58, v59
    v_cvt_pk_bf16_f32 v82, v60, v61
    v_cvt_pk_bf16_f32 v83, v62, v63
    v_cvt_pk_bf16_f32 v84, v64, v65
    v_cvt_pk_bf16_f32 v85, v66, v67
    v_cvt_pk_bf16_f32 v86, v68, v69
    v_cvt_pk_bf16_f32 v87, v70, v71
    ds_write_addtid_b32 v72 offset:29952
    ds_write_addtid_b32 v73 offset:30224
    ds_write_addtid_b32 v74 offset:30496
    ds_write_addtid_b32 v75 offset:30768
    ds_write_addtid_b32 v76 offset:31040
    ds_write_addtid_b32 v77 offset:31312
    ds_write_addtid_b32 v78 offset:31584
    ds_write_addtid_b32 v79 offset:31856
    ds_write_addtid_b32 v80 offset:32128
    ds_write_addtid_b32 v81 offset:32400
    ds_write_addtid_b32 v82 offset:32672
    ds_write_addtid_b32 v83 offset:32944
    ds_write_addtid_b32 v84 offset:33216
    ds_write_addtid_b32 v85 offset:33488
    ds_write_addtid_b32 v86 offset:33760
    ds_write_addtid_b32 v87 offset:34032
    ds_read_b128 v[40:43], v35 offset:0
    ds_read_b128 v[44:47], v35 offset:32
    ds_read_b128 v[48:51], v35 offset:64
    ds_read_b128 v[52:55], v35 offset:96
    ds_read_b128 v[56:59], v35 offset:128
    ds_read_b128 v[60:63], v35 offset:160
    ds_read_b128 v[64:67], v35 offset:192
    ds_read_b128 v[68:71], v35 offset:224
    v_pk_mul_f32 v[112:113], v[104:105], v[98:99] op_sel:[0,0] op_sel_hi:[0,1]
    v_pk_mul_f32 v[114:115], v[106:107], v[98:99] op_sel:[0,0] op_sel_hi:[0,1]
    v_pk_mul_f32 v[116:117], v[108:109], v[98:99] op_sel:[0,0] op_sel_hi:[0,1]
    v_pk_mul_f32 v[118:119], v[110:111], v[98:99] op_sel:[0,0] op_sel_hi:[0,1]
    v_pk_mul_f32 v[120:121], v[104:105], v[90:91] op_sel:[0,0] op_sel_hi:[0,1]
    v_pk_mul_f32 v[122:123], v[108:109], v[90:91] op_sel:[0,0] op_sel_hi:[0,1]
    v_pk_mul_f32 v[128:129], v[104:105], v[100:101] op_sel:[0,0] op_sel_hi:[0,1]
    v_pk_fma_f32 v[112:113], v[104:105], v[98:99], v[112:113] op_sel:[1,1,0] op_sel_hi:[1,0,1] neg_lo:[1,0,0]
    v_pk_fma_f32 v[114:115], v[106:107], v[98:99], v[114:115] op_sel:[1,1,0] op_sel_hi:[1,0,1] neg_lo:[1,0,0]
    v_pk_fma_f32 v[116:117], v[108:109], v[98:99], v[116:117] op_sel:[1,1,0] op_sel_hi:[1,0,1] neg_lo:[1,0,0]
    v_pk_fma_f32 v[118:119], v[110:111], v[98:99], v[118:119] op_sel:[1,1,0] op_sel_hi:[1,0,1] neg_lo:[1,0,0]
    v_pk_fma_f32 v[120:121], v[104:105], v[90:91], v[120:121] op_sel:[1,1,0] op_sel_hi:[1,0,1] neg_lo:[1,0,0]
    v_pk_fma_f32 v[122:123], v[108:109], v[90:91], v[122:123] op_sel:[1,1,0] op_sel_hi:[1,0,1] neg_lo:[1,0,0]
    v_pk_fma_f32 v[128:129], v[104:105], v[100:101], v[128:129] op_sel:[1,1,0] op_sel_hi:[1,0,1] neg_lo:[1,0,0]
    v_pk_mul_f32 v[124:125], v[112:113], v[90:91] op_sel:[0,0] op_sel_hi:[0,1]
    v_pk_mul_f32 v[126:127], v[116:117], v[90:91] op_sel:[0,0] op_sel_hi:[0,1]
    v_pk_mul_f32 v[130:131], v[112:113], v[100:101] op_sel:[0,0] op_sel_hi:[0,1]
    v_pk_mul_f32 v[132:133], v[120:121], v[100:101] op_sel:[0,0] op_sel_hi:[0,1]
    v_pk_mul_f32 v[136:137], v[128:129], v[100:101] op_sel:[0,0] op_sel_hi:[0,1]
    v_pk_fma_f32 v[124:125], v[112:113], v[90:91], v[124:125] op_sel:[1,1,0] op_sel_hi:[1,0,1] neg_lo:[1,0,0]
    v_pk_fma_f32 v[126:127], v[116:117], v[90:91], v[126:127] op_sel:[1,1,0] op_sel_hi:[1,0,1] neg_lo:[1,0,0]
    v_pk_fma_f32 v[130:131], v[112:113], v[100:101], v[130:131] op_sel:[1,1,0] op_sel_hi:[1,0,1] neg_lo:[1,0,0]
    v_pk_fma_f32 v[132:133], v[120:121], v[100:101], v[132:133] op_sel:[1,1,0] op_sel_hi:[1,0,1] neg_lo:[1,0,0]
    v_pk_fma_f32 v[136:137], v[128:129], v[100:101], v[136:137] op_sel:[1,1,0] op_sel_hi:[1,0,1] neg_lo:[1,0,0]
    v_pk_mul_f32 v[134:135], v[124:125], v[100:101] op_sel:[0,0] op_sel_hi:[0,1]
    v_pk_mul_f32 v[138:139], v[132:133], v[100:101] op_sel:[0,0] op_sel_hi:[0,1]
    v_pk_mul_f32 v[140:141], v[136:137], v[100:101] op_sel:[0,0] op_sel_hi:[0,1]
    v_pk_fma_f32 v[134:135], v[124:125], v[100:101], v[134:135] op_sel:[1,1,0] op_sel_hi:[1,0,1] neg_lo:[1,0,0]
    v_pk_fma_f32 v[138:139], v[132:133], v[100:101], v[138:139] op_sel:[1,1,0] op_sel_hi:[1,0,1] neg_lo:[1,0,0]
    v_pk_fma_f32 v[140:141], v[136:137], v[100:101], v[140:141] op_sel:[1,1,0] op_sel_hi:[1,0,1] neg_lo:[1,0,0]
    v_pk_mul_f32 v[144:145], v[138:139], v[100:101] op_sel:[0,0] op_sel_hi:[0,1]
    v_pk_mul_f32 v[146:147], v[140:141], v[100:101] op_sel:[0,0] op_sel_hi:[0,1]
    v_pk_fma_f32 v[144:145], v[138:139], v[100:101], v[144:145] op_sel:[1,1,0] op_sel_hi:[1,0,1] neg_lo:[1,0,0]
    v_pk_fma_f32 v[146:147], v[140:141], v[100:101], v[146:147] op_sel:[1,1,0] op_sel_hi:[1,0,1] neg_lo:[1,0,0]
    v_cvt_pk_bf16_f32 v72, v104, -v105
    v_cvt_pk_bf16_f32 v73, v106, -v107
    v_cvt_pk_bf16_f32 v74, v108, -v109
    v_cvt_pk_bf16_f32 v75, v110, -v111
    v_cvt_pk_bf16_f32 v76, v112, -v113
    v_cvt_pk_bf16_f32 v77, v114, -v115
    v_cvt_pk_bf16_f32 v78, v116, -v117
    v_cvt_pk_bf16_f32 v79, v118, -v119
    v_cvt_pk_bf16_f32 v80, v120, -v121
    v_cvt_pk_bf16_f32 v81, v122, -v123
    v_cvt_pk_bf16_f32 v82, v124, -v125
    v_cvt_pk_bf16_f32 v83, v126, -v127
    v_cvt_pk_bf16_f32 v84, v128, -v129
    v_cvt_pk_bf16_f32 v85, v130, -v131
    v_cvt_pk_bf16_f32 v86, v132, -v133
    v_cvt_pk_bf16_f32 v87, v134, -v135
    v_cvt_pk_bf16_f32 v88, v136, -v137
    v_cvt_pk_bf16_f32 v89, v138, -v139
    v_cvt_pk_bf16_f32 v90, v140, -v141
    v_cvt_pk_bf16_f32 v91, v144, -v145
    v_cvt_pk_bf16_f32 v92, v146, -v147
    ds_write_addtid_b32 v72 offset:34304
    ds_write_addtid_b32 v73 offset:34576
    ds_write_addtid_b32 v74 offset:34848
    ds_write_addtid_b32 v75 offset:35120
    ds_write_addtid_b32 v76 offset:35392
    ds_write_addtid_b32 v77 offset:35664
    ds_write_addtid_b32 v78 offset:35936
    ds_write_addtid_b32 v79 offset:36208
    ds_write_addtid_b32 v80 offset:36480
    ds_write_addtid_b32 v81 offset:36752
    ds_write_addtid_b32 v82 offset:37024
    ds_write_addtid_b32 v83 offset:37296
    ds_write_addtid_b32 v84 offset:37568
    ds_write_addtid_b32 v85 offset:37840
    ds_write_addtid_b32 v86 offset:38112
    ds_write_addtid_b32 v87 offset:38384
    ds_write_addtid_b32 v88 offset:38656
    ds_write_addtid_b32 v89 offset:38928
    ds_write_addtid_b32 v90 offset:39200
    ds_write_addtid_b32 v91 offset:39744
    ds_write_addtid_b32 v92 offset:40016
    ds_read_b128 v[148:151], v35 offset:8704
    ds_read_b128 v[152:155], v35 offset:8736
    ds_read_b128 v[156:159], v35 offset:8768
    ds_read_b128 v[160:163], v35 offset:8800
    ds_read_b128 v[164:167], v35 offset:8832
    ds_read_b128 v[168:171], v35 offset:8864
    ds_read_b128 v[172:175], v35 offset:8896
    ds_read_b128 v[176:179], v35 offset:8928
    s_waitcnt lgkmcnt(7)
    v_mfma_f32_32x32x16_bf16 v[180:195], v[148:151], v[40:43], 0
    s_waitcnt lgkmcnt(6)
    v_mfma_f32_32x32x16_bf16 v[180:195], v[152:155], v[44:47], v[180:195]
    s_waitcnt lgkmcnt(5)
    v_mfma_f32_32x32x16_bf16 v[180:195], v[156:159], v[48:51], v[180:195]
    s_waitcnt lgkmcnt(4)
    v_mfma_f32_32x32x16_bf16 v[180:195], v[160:163], v[52:55], v[180:195]
    s_waitcnt lgkmcnt(3)
    v_mfma_f32_32x32x16_bf16 v[180:195], v[164:167], v[56:59], v[180:195]
    s_waitcnt lgkmcnt(2)
    v_mfma_f32_32x32x16_bf16 v[180:195], v[168:171], v[60:63], v[180:195]
    s_waitcnt lgkmcnt(1)
    v_mfma_f32_32x32x16_bf16 v[180:195], v[172:175], v[64:67], v[180:195]
    s_waitcnt lgkmcnt(0)
    v_mfma_f32_32x32x16_bf16 v[180:195], v[176:179], v[68:71], v[180:195]
    s_add_u32 s75, s75, 4
    s_nop 10
    ds_write_b128 v8, v[180:183]
    ds_write_b64 v9, v[184:185]
    ds_write_b64 v10, v[186:187]
    ds_write_b32 v11, v188 offset:2048
    ds_write_b32 v11, v189 offset:2176
    ds_write_b32 v11, v190 offset:2304
    v_add_u32 v8, 11264, v8
    v_add_u32 v9, 11264, v9
    v_add_u32 v10, 11264, v10
    v_add_u32 v11, 11264, v11
    s_cmp_ge_u32 s75, 8
    s_cbranch_scc1 KG2
    s_waitcnt vmcnt(0)
    s_barrier
    s_cmp_eq_u32 s3, 0
    s_cbranch_scc1 W1J0
    s_cmp_eq_u32 s3, 1
    s_cbranch_scc1 PRE1
    ds_read2_b32 v[40:41], v225 offset0:0 offset1:1
    ds_read2_b32 v[42:43], v226 offset0:0 offset1:1
    ds_read2_b32 v[44:45], v225 offset0:20 offset1:21
    ds_read2_b32 v[46:47], v226 offset0:20 offset1:21
    ds_read2_b32 v[48:49], v225 offset0:40 offset1:41
    ds_read2_b32 v[50:51], v226 offset0:40 offset1:41
    ds_read2_b32 v[52:53], v225 offset0:60 offset1:61
    ds_read2_b32 v[54:55], v226 offset0:60 offset1:61
    ds_read2_b32 v[56:57], v225 offset0:80 offset1:81
    ds_read2_b32 v[58:59], v226 offset0:80 offset1:81
    ds_read2_b32 v[60:61], v225 offset0:100 offset1:101
    ds_read2_b32 v[62:63], v226 offset0:100 offset1:101
    ds_read2_b32 v[64:65], v225 offset0:120 offset1:121
    ds_read2_b32 v[66:67], v226 offset0:120 offset1:121
    ds_read2_b32 v[68:69], v225 offset0:140 offset1:141
    ds_read2_b32 v[70:71], v226 offset0:140 offset1:141
    s_and_b32 s78, s3, 1
    s_lshl_b32 s78, s78, 21
    s_lshl_b32 s79, s2, 6
    s_add_u32 s78, s78, s79
    s_add_u32 s78, s78, 0x100000
    s_mov_b32 s72, 0x05040100
    s_mov_b32 s73, 0x07060302
    v_mov_b32 v107, s56
    v_mov_b32 v111, s56
    v_mov_b32 v115, s56
    v_mov_b32 v119, s56
    v_mov_b32 v123, s56
    v_mov_b32 v127, s56
    v_mov_b32 v131, s56
    v_mov_b32 v135, s56
    s_waitcnt lgkmcnt(15)
    v_perm_b32 v32, v41, v40, v227
    s_waitcnt lgkmcnt(14)
    v_perm_b32 v33, v43, v42, v227
    v_perm_b32 v34, v41, v40, v228
    v_perm_b32 v38, v43, v42, v228
    v_perm_b32 v104, v33, v32, s72
    v_perm_b32 v105, v33, v32, s73
    v_perm_b32 v106, v38, v34, s72
    buffer_store_dwordx4 v[104:107], v224, s[36:39], s78 offen sc1
    s_add_u32 s78, s78, 262144
    s_waitcnt lgkmcnt(13)
    v_perm_b32 v32, v45, v44, v227
    s_waitcnt lgkmcnt(12)
    v_perm_b32 v33, v47, v46, v227
    v_perm_b32 v34, v45, v44, v228
    v_perm_b32 v38, v47, v46, v228
    v_perm_b32 v108, v33, v32, s72
    v_perm_b32 v109, v33, v32, s73
    v_perm_b32 v110, v38, v34, s72
    buffer_store_dwordx4 v[108:111], v224, s[36:39], s78 offen sc1
    s_add_u32 s78, s78, 262144
    s_waitcnt lgkmcnt(11)
    v_perm_b32 v32, v49, v48, v227
    s_waitcnt lgkmcnt(10)
    v_perm_b32 v33, v51, v50, v227
    v_perm_b32 v34, v49, v48, v228
    v_perm_b32 v38, v51, v50, v228
    v_perm_b32 v112, v33, v32, s72
    v_perm_b32 v113, v33, v32, s73
    v_perm_b32 v114, v38, v34, s72
    buffer_store_dwordx4 v[112:115], v224, s[36:39], s78 offen sc1
    s_add_u32 s78, s78, 262144
    s_waitcnt lgkmcnt(9)
    v_perm_b32 v32, v53, v52, v227
    s_waitcnt lgkmcnt(8)
    v_perm_b32 v33, v55, v54, v227
    v_perm_b32 v34, v53, v52, v228
    v_perm_b32 v38, v55, v54, v228
    v_perm_b32 v116, v33, v32, s72
    v_perm_b32 v117, v33, v32, s73
    v_perm_b32 v118, v38, v34, s72
    buffer_store_dwordx4 v[116:119], v224, s[36:39], s78 offen sc1
    s_add_u32 s78, s78, 262144
    s_waitcnt lgkmcnt(7)
    v_perm_b32 v32, v57, v56, v227
    s_waitcnt lgkmcnt(6)
    v_perm_b32 v33, v59, v58, v227
    v_perm_b32 v34, v57, v56, v228
    v_perm_b32 v38, v59, v58, v228
    v_perm_b32 v120, v33, v32, s72
    v_perm_b32 v121, v33, v32, s73
    v_perm_b32 v122, v38, v34, s72
    buffer_store_dwordx4 v[120:123], v224, s[36:39], s78 offen sc1
    s_add_u32 s78, s78, 262144
    s_waitcnt lgkmcnt(5)
    v_perm_b32 v32, v61, v60, v227
    s_waitcnt lgkmcnt(4)
    v_perm_b32 v33, v63, v62, v227
    v_perm_b32 v34, v61, v60, v228
    v_perm_b32 v38, v63, v62, v228
    v_perm_b32 v124, v33, v32, s72
    v_perm_b32 v125, v33, v32, s73
    v_perm_b32 v126, v38, v34, s72
    buffer_store_dwordx4 v[124:127], v224, s[36:39], s78 offen sc1
    s_add_u32 s78, s78, 262144
    s_waitcnt lgkmcnt(3)
    v_perm_b32 v32, v65, v64, v227
    s_waitcnt lgkmcnt(2)
    v_perm_b32 v33, v67, v66, v227
    v_perm_b32 v34, v65, v64, v228
    v_perm_b32 v38, v67, v66, v228
    v_perm_b32 v128, v33, v32, s72
    v_perm_b32 v129, v33, v32, s73
    v_perm_b32 v130, v38, v34, s72
    buffer_store_dwordx4 v[128:131], v224, s[36:39], s78 offen sc1
    s_add_u32 s78, s78, 262144
    s_waitcnt lgkmcnt(1)
    v_perm_b32 v32, v69, v68, v227
    s_waitcnt lgkmcnt(0)
    v_perm_b32 v33, v71, v70, v227
    v_perm_b32 v34, v69, v68, v228
    v_perm_b32 v38, v71, v70, v228
    v_perm_b32 v132, v33, v32, s72
    v_perm_b32 v133, v33, v32, s73
    v_perm_b32 v134, v38, v34, s72
    buffer_store_dwordx4 v[132:135], v224, s[36:39], s78 offen sc1
    s_waitcnt vmcnt(9)
    s_branch W1J
PRE1:
    ds_read_b128 v[40:43], v229 offset:0
    ds_read_b128 v[44:47], v229 offset:128
    ds_read_b128 v[48:51], v229 offset:256
    ds_read_b128 v[52:55], v229 offset:384
    ds_read_b128 v[56:59], v229 offset:512
    ds_read_b128 v[60:63], v229 offset:640
    ds_read_b128 v[64:67], v229 offset:768
    ds_read_b128 v[68:71], v229 offset:896
    ds_read_b128 v[72:75], v229 offset:1024
    ds_read_b128 v[76:79], v229 offset:1152
    v_and_b32 v38, 15, v240
    v_cmp_eq_u32 vcc, 0, v38
    v_mov_b32 v38, 0x7ffffff0
    v_mov_b32 v107, s56
    v_cndmask_b32 v38, v38, v240, vcc
    s_lshl_b32 s78, s2, 6
    s_add_u32 s78, s78, 0x60000
    s_waitcnt lgkmcnt(9)
    v_dot2_f32_bf16 v32, v40, s65, 0
    v_dot2_f32_bf16 v33, v40, v40, 0
    v_dot2_f32_bf16 v32, v41, s65, v32
    v_dot2_f32_bf16 v33, v41, v41, v33
    v_dot2_f32_bf16 v32, v42, s65, v32
    v_dot2_f32_bf16 v33, v42, v42, v33
    v_dot2_f32_bf16 v32, v43, s65, v32
    v_dot2_f32_bf16 v33, v43, v43, v33
    s_waitcnt lgkmcnt(8)
    s_nop 0
    v_dot2_f32_bf16 v32, v44, s65, v32
    v_dot2_f32_bf16 v33, v44, v44, v33
    v_dot2_f32_bf16 v32, v45, s65, v32
    v_dot2_f32_bf16 v33, v45, v45, v33
    v_dot2_f32_bf16 v32, v46, s65, v32
    v_dot2_f32_bf16 v33, v46, v46, v33
    v_dot2_f32_bf16 v32, v47, s65, v32
    v_dot2_f32_bf16 v33, v47, v47, v33
    s_waitcnt lgkmcnt(7)
    s_nop 0
    v_dot2_f32_bf16 v32, v48, s65, v32
    v_dot2_f32_bf16 v33, v48, v48, v33
    v_dot2_f32_bf16 v32, v49, s65, v32
    v_dot2_f32_bf16 v33, v49, v49, v33
    v_dot2_f32_bf16 v32, v50, s65, v32
    v_dot2_f32_bf16 v33, v50, v50, v33
    v_dot2_f32_bf16 v32, v51, s65, v32
    v_dot2_f32_bf16 v33, v51, v51, v33
    s_waitcnt lgkmcnt(6)
    s_nop 0
    v_dot2_f32_bf16 v32, v52, s65, v32
    v_dot2_f32_bf16 v33, v52, v52, v33
    v_dot2_f32_bf16 v32, v53, s65, v32
    v_dot2_f32_bf16 v33, v53, v53, v33
    v_dot2_f32_bf16 v32, v54, s65, v32
    v_dot2_f32_bf16 v33, v54, v54, v33
    v_dot2_f32_bf16 v32, v55, s65, v32
    v_dot2_f32_bf16 v33, v55, v55, v33
    s_waitcnt lgkmcnt(5)
    s_nop 0
    v_dot2_f32_bf16 v32, v56, s65, v32
    v_dot2_f32_bf16 v33, v56, v56, v33
    v_dot2_f32_bf16 v32, v57, s65, v32
    v_dot2_f32_bf16 v33, v57, v57, v33
    v_dot2_f32_bf16 v32, v58, s65, v32
    v_dot2_f32_bf16 v33, v58, v58, v33
    v_dot2_f32_bf16 v32, v59, s65, v32
    v_dot2_f32_bf16 v33, v59, v59, v33
    s_waitcnt lgkmcnt(4)
    s_nop 0
    v_dot2_f32_bf16 v32, v60, s65, v32
    v_dot2_f32_bf16 v33, v60, v60, v33
    v_dot2_f32_bf16 v32, v61, s65, v32
    v_dot2_f32_bf16 v33, v61, v61, v33
    v_dot2_f32_bf16 v32, v62, s65, v32
    v_dot2_f32_bf16 v33, v62, v62, v33
    v_dot2_f32_bf16 v32, v63, s65, v32
    v_dot2_f32_bf16 v33, v63, v63, v33
    s_waitcnt lgkmcnt(3)
    s_nop 0
    v_dot2_f32_bf16 v32, v64, s65, v32
    v_dot2_f32_bf16 v33, v64, v64, v33
    v_dot2_f32_bf16 v32, v65, s65, v32
    v_dot2_f32_bf16 v33, v65, v65, v33
    v_dot2_f32_bf16 v32, v66, s65, v32
    v_dot2_f32_bf16 v33, v66, v66, v33
    v_dot2_f32_bf16 v32, v67, s65, v32
    v_dot2_f32_bf16 v33, v67, v67, v33
    s_waitcnt lgkmcnt(2)
    s_nop 0
    v_dot2_f32_bf16 v32, v68, s65, v32
    v_dot2_f32_bf16 v33, v68, v68, v33
    v_dot2_f32_bf16 v32, v69, s65, v32
    v_dot2_f32_bf16 v33, v69, v69, v33
    v_dot2_f32_bf16 v32, v70, s65, v32
    v_dot2_f32_bf16 v33, v70, v70, v33
    v_dot2_f32_bf16 v32, v71, s65, v32
    v_dot2_f32_bf16 v33, v71, v71, v33
    s_waitcnt lgkmcnt(1)
    s_nop 0
    v_dot2_f32_bf16 v32, v72, s65, v32
    v_dot2_f32_bf16 v33, v72, v72, v33
    v_dot2_f32_bf16 v32, v73, s65, v32
    v_dot2_f32_bf16 v33, v73, v73, v33
    v_dot2_f32_bf16 v32, v74, s65, v32
    v_dot2_f32_bf16 v33, v74, v74, v33
    v_dot2_f32_bf16 v32, v75, s65, v32
    v_dot2_f32_bf16 v33, v75, v75, v33
    s_waitcnt lgkmcnt(0)
    s_nop 0
    v_dot2_f32_bf16 v32, v76, s65, v32
    v_dot2_f32_bf16 v33, v76, v76, v33
    v_dot2_f32_bf16 v32, v77, s65, v32
    v_dot2_f32_bf16 v33, v77, v77, v33
    v_dot2_f32_bf16 v32, v78, s65, v32
    v_dot2_f32_bf16 v33, v78, v78, v33
    v_dot2_f32_bf16 v32, v79, s65, v32
    v_dot2_f32_bf16 v33, v79, v79, v33
    s_nop 1
    v_add_f32_dpp v32, v32, v32 quad_perm:[1,0,3,2] row_mask:0xf bank_mask:0xf
    v_add_f32_dpp v33, v33, v33 quad_perm:[1,0,3,2] row_mask:0xf bank_mask:0xf
    s_nop 0
    v_add_f32_dpp v32, v32, v32 quad_perm:[2,3,0,1] row_mask:0xf bank_mask:0xf
    v_add_f32_dpp v33, v33, v33 quad_perm:[2,3,0,1] row_mask:0xf bank_mask:0xf
    s_nop 0
    v_add_f32_dpp v32, v32, v32 row_half_mirror row_mask:0xf bank_mask:0xf
    v_add_f32_dpp v33, v33, v33 row_half_mirror row_mask:0xf bank_mask:0xf
    v_mul_f32 v32, 0x3acccccd, v32
    v_mul_f32 v33, 0x3acccccd, v33
    v_fma_f32 v33, -v32, v32, v33
    v_max_f32 v33, 0, v33
    v_cvt_pk_bf16_f32 v34, v33, v33
    v_lshlrev_b32_e64 v33, 16, v34
    v_add_f32 v33, 0x3727c5ac, v33
    v_cvt_pk_bf16_f32 v34, v33, v33
    v_lshlrev_b32 v33, 16, v34
    v_sqrt_f32 v33, v33
    s_nop 0
    v_cvt_pk_bf16_f32 v34, v33, v33
    v_lshlrev_b32 v33, 16, v34
    v_rcp_f32 v33, v33
    s_nop 0
    v_mov_b32_e64 v104, v33
    v_mov_b32_dpp v105, v33 row_ror:8 row_mask:0xf bank_mask:0xf
    v_mov_b32_dpp v34, v32 row_ror:8 row_mask:0xf bank_mask:0xf
    v_cvt_pk_bf16_f32 v106, v32, v34
    buffer_store_dwordx4 v[104:107], v38, s[36:39], s78 offen sc1
    s_waitcnt vmcnt(2)
    s_branch W1J
W1J0:
    s_waitcnt vmcnt(1)
    s_nop 0
W1J:
KNEXT:
    v_pk_mov_b32 v[200:201], v[208:209], v[208:209] op_sel:[0,1]
    v_pk_mov_b32 v[202:203], v[210:211], v[210:211] op_sel:[0,1]
    v_pk_mov_b32 v[204:205], v[212:213], v[212:213] op_sel:[0,1]
    v_pk_mov_b32 v[206:207], v[214:215], v[214:215] op_sel:[0,1]
    v_pk_mov_b32 v[208:209], v[216:217], v[216:217] op_sel:[0,1]
    v_pk_mov_b32 v[210:211], v[218:219], v[218:219] op_sel:[0,1]
    v_pk_mov_b32 v[212:213], v[220:221], v[220:221] op_sel:[0,1]
    v_pk_mov_b32 v[214:215], v[222:223], v[222:223] op_sel:[0,1]
    s_branch KGEN
KG2:
    s_cmp_eq_u32 s75, 8
    s_cbranch_scc1 KNEXT
KDONE:
    s_waitcnt lgkmcnt(0)
    s_barrier
    s_mov_b32 s73, s20
    s_mov_b32 s74, 0x60000
    buffer_load_dwordx4 v[196:199], v1, s[36:39], s73 offen sc1
    buffer_load_dwordx4 v[212:215], v1, s[36:39], s74 offen sc1
    s_add_u32 s73, s73, 4096
    s_add_u32 s74, s74, 4096
    buffer_load_dwordx4 v[200:203], v1, s[36:39], s73 offen sc1
    buffer_load_dwordx4 v[216:219], v1, s[36:39], s74 offen sc1
    s_add_u32 s73, s73, 4096
    s_add_u32 s74, s74, 4096
    buffer_load_dwordx4 v[204:207], v1, s[36:39], s73 offen sc1
    buffer_load_dwordx4 v[220:223], v1, s[36:39], s74 offen sc1
    s_add_u32 s73, s73, 4096
    s_add_u32 s74, s74, 4096
    buffer_load_dwordx4 v[208:211], v1, s[36:39], s73 offen sc1
    buffer_load_dwordx4 v[224:227], v1, s[36:39], s74 offen sc1
    s_add_u32 m0, s64, 0
    s_nop 0
    buffer_load_dwordx4 v250, s[44:47], s4 offen lds
    s_add_u32 m0, s64, 2048
    s_nop 0
    buffer_load_dwordx4 v251, s[48:51], s4 offen lds
    s_add_u32 m0, s64, 1024
    s_nop 0
    buffer_load_dwordx4 v250, s[44:47], s5 offen lds
    s_add_u32 m0, s64, 3072
    s_nop 0
    buffer_load_dwordx4 v251, s[48:51], s5 offen lds
    s_lshl_b32 s72, s2, 2
    s_add_u32 s72, s72, s3
    s_mul_i32 s72, s72, 15
    v_min_u32_e64 v44, 14, v240
    v_add_lshl_u32 v44, v44, s72, 7
    buffer_load_dword v253, v44, s[40:43], 0 offen
    s_cmp_eq_u32 s3, 3
    s_cbranch_scc1 NOPAD
    v_mov_b32 v40, 0
    v_mov_b32 v41, 0
    v_mov_b32 v42, 0
    v_mov_b32 v43, 0
    s_mul_i32 s75, s3, 18944
    s_add_u32 s75, s75, 83200
    v_add_u32 v16, s75, v241
    v_and_b32 v17, 48, v241
    v_add_u32 v17, s75, v17
    v_mov_b32 v18, s75
    ds_write_b128 v16, v[40:43] offset:0
    ds_write_b128 v16, v[40:43] offset:5152
    ds_write_b128 v17, v[40:43] offset:14400
    ds_write_b128 v17, v[40:43] offset:18624
    ds_write_b32 v18, v40 offset:6176
NOPAD:
    v_cmp_eq_u32 vcc, 0, v240
    s_cmp_eq_u32 s3, 0
    s_cbranch_scc0 EXPN
    v_subrev_u32 v17, 4, v241
    v_max_i32_e64 v17, 0, v17
    ds_read_b128 v[44:47], v241 offset:0
    ds_read_b32 v56, v17 offset:0
    ds_read_b128 v[48:51], v241 offset:2816
    ds_read_b32 v57, v17 offset:2816
    ds_read_b128 v[52:55], v241 offset:5632
    ds_read_b32 v58, v17 offset:5632
    ds_read_b128 v[60:63], v241 offset:8448
    ds_read_b32 v72, v17 offset:8448
    ds_read_b128 v[64:67], v241 offset:11264
    ds_read_b32 v73, v17 offset:11264
    ds_read_b128 v[68:71], v241 offset:14080
    ds_read_b32 v74, v17 offset:14080
    ds_read_b128 v[76:79], v241 offset:16896
    ds_read_b32 v88, v17 offset:16896
    ds_read_b128 v[80:83], v241 offset:19712
    ds_read_b32 v89, v17 offset:19712
    ds_read_b128 v[84:87], v241 offset:22528
    ds_read_b32 v90, v17 offset:22528
    v_lshlrev_b32_e64 v18, 3, v240
    v_sub_u32 v18, 97592, v18
    s_waitcnt lgkmcnt(15)
    v_pk_add_f32 v[44:45], v[44:45], v[48:49]
    v_pk_add_f32 v[46:47], v[46:47], v[50:51]
    s_waitcnt lgkmcnt(14)
    v_add_f32 v56, v56, v57
    s_waitcnt lgkmcnt(13)
    v_pk_add_f32 v[44:45], v[44:45], v[52:53]
    v_pk_add_f32 v[46:47], v[46:47], v[54:55]
    s_waitcnt lgkmcnt(12)
    v_add_f32 v56, v56, v58
    v_cndmask_b32 v56, v56, 0, vcc
    v_cvt_pk_bf16_f32 v96, v47, v46
    v_cvt_pk_bf16_f32 v97, v45, v44
    v_cvt_pk_bf16_f32 v98, v46, v45
    v_cvt_pk_bf16_f32 v99, v44, v56
    ds_write_b64 v18, v[96:97] offset:0
    ds_write_b64 v18, v[98:99] offset:4224
    s_waitcnt lgkmcnt(11)
    v_pk_add_f32 v[60:61], v[60:61], v[64:65]
    v_pk_add_f32 v[62:63], v[62:63], v[66:67]
    s_waitcnt lgkmcnt(10)
    v_add_f32 v72, v72, v73
    s_waitcnt lgkmcnt(9)
    v_pk_add_f32 v[60:61], v[60:61], v[68:69]
    v_pk_add_f32 v[62:63], v[62:63], v[70:71]
    s_waitcnt lgkmcnt(8)
    v_add_f32 v72, v72, v74
    v_cndmask_b32 v72, v72, 0, vcc
    v_cvt_pk_bf16_f32 v100, v63, v62
    v_cvt_pk_bf16_f32 v101, v61, v60
    v_cvt_pk_bf16_f32 v102, v62, v61
    v_cvt_pk_bf16_f32 v103, v60, v72
    ds_write_b64 v18, v[100:101] offset:18944
    ds_write_b64 v18, v[102:103] offset:23168
    s_waitcnt lgkmcnt(7)
    v_pk_add_f32 v[76:77], v[76:77], v[80:81]
    v_pk_add_f32 v[78:79], v[78:79], v[82:83]
    s_waitcnt lgkmcnt(6)
    v_add_f32 v88, v88, v89
    s_waitcnt lgkmcnt(5)
    v_pk_add_f32 v[76:77], v[76:77], v[84:85]
    v_pk_add_f32 v[78:79], v[78:79], v[86:87]
    s_waitcnt lgkmcnt(4)
    v_add_f32 v88, v88, v90
    v_cndmask_b32 v88, v88, 0, vcc
    v_cvt_pk_bf16_f32 v104, v79, v78
    v_cvt_pk_bf16_f32 v105, v77, v76
    v_cvt_pk_bf16_f32 v106, v78, v77
    v_cvt_pk_bf16_f32 v107, v76, v88
    ds_write_b64 v18, v[104:105] offset:37888
    ds_write_b64 v18, v[106:107] offset:42112
    s_branch EXPD
EXPN:
    s_lshl_b32 s75, s3, 9
    s_add_u32 s75, s75, 508
    v_lshlrev_b32 v16, 3, v240
    v_add_u32 v16, s75, v16
    ds_read_b64 v[44:45], v16 offset:4
    ds_read_b32 v46, v16 offset:12
    ds_read_b32 v47, v16 offset:0
    ds_read_b64 v[48:49], v16 offset:2820
    ds_read_b32 v50, v16 offset:2828
    ds_read_b32 v51, v16 offset:2816
    ds_read_b64 v[52:53], v16 offset:5636
    ds_read_b32 v54, v16 offset:5644
    ds_read_b32 v55, v16 offset:5632
    ds_read_b64 v[56:57], v16 offset:8452
    ds_read_b32 v58, v16 offset:8460
    ds_read_b32 v59, v16 offset:8448
    ds_read_b64 v[60:61], v16 offset:11268
    ds_read_b32 v62, v16 offset:11276
    ds_read_b32 v63, v16 offset:11264
    ds_read_b64 v[64:65], v16 offset:14084
    ds_read_b32 v66, v16 offset:14092
    ds_read_b32 v67, v16 offset:14080
    ds_read_b64 v[68:69], v16 offset:16900
    ds_read_b32 v70, v16 offset:16908
    ds_read_b32 v71, v16 offset:16896
    ds_read_b64 v[72:73], v16 offset:19716
    ds_read_b32 v74, v16 offset:19724
    ds_read_b32 v75, v16 offset:19712
    ds_read_b64 v[76:77], v16 offset:22532
    ds_read_b32 v78, v16 offset:22540
    ds_read_b32 v79, v16 offset:22528
    s_waitcnt lgkmcnt(15)
    v_pk_add_f32 v[44:45], v[44:45], v[48:49]
    v_pk_add_f32 v[46:47], v[46:47], v[50:51]
    v_pk_add_f32 v[44:45], v[44:45], v[52:53]
    v_pk_add_f32 v[46:47], v[46:47], v[54:55]
    s_waitcnt lgkmcnt(14)
    v_pk_add_f32 v[56:57], v[56:57], v[60:61]
    s_waitcnt lgkmcnt(12)
    v_pk_add_f32 v[58:59], v[58:59], v[62:63]
    s_waitcnt lgkmcnt(11)
    v_pk_add_f32 v[56:57], v[56:57], v[64:65]
    s_waitcnt lgkmcnt(9)
    v_pk_add_f32 v[58:59], v[58:59], v[66:67]
    s_waitcnt lgkmcnt(5)
    v_pk_add_f32 v[68:69], v[68:69], v[72:73]
    s_waitcnt lgkmcnt(3)
    v_pk_add_f32 v[70:71], v[70:71], v[74:75]
    s_waitcnt lgkmcnt(2)
    v_pk_add_f32 v[68:69], v[68:69], v[76:77]
    s_waitcnt lgkmcnt(0)
    v_pk_add_f32 v[70:71], v[70:71], v[78:79]
    s_cmp_eq_u32 s3, 2
    s_cbranch_scc1 EXP2
    s_cmp_eq_u32 s3, 3
    s_cbranch_scc1 EXP3
    v_lshlrev_b32 v18, 3, v240
    v_sub_u32 v18, 97080, v18
    v_cndmask_b32_e64 v47, v44, v47, vcc
    v_cvt_pk_bf16_f32 v96, v46, v45
    v_cvt_pk_bf16_f32 v97, v44, v44
    v_cvt_pk_bf16_f32 v98, v45, v44
    v_cvt_pk_bf16_f32 v99, v44, v47
    ds_write_b64 v18, v[96:97] offset:0
    ds_write_b64 v18, v[98:99] offset:4224
    v_cndmask_b32_e64 v59, v56, v59, vcc
    v_cvt_pk_bf16_f32 v100, v58, v57
    v_cvt_pk_bf16_f32 v101, v56, v56
    v_cvt_pk_bf16_f32 v102, v57, v56
    v_cvt_pk_bf16_f32 v103, v56, v59
    ds_write_b64 v18, v[100:101] offset:18944
    ds_write_b64 v18, v[102:103] offset:23168
    v_cndmask_b32_e64 v71, v68, v71, vcc
    v_cvt_pk_bf16_f32 v104, v70, v69
    v_cvt_pk_bf16_f32 v105, v68, v68
    v_cvt_pk_bf16_f32 v106, v69, v68
    v_cvt_pk_bf16_f32 v107, v68, v71
    ds_write_b64 v18, v[104:105] offset:37888
    ds_write_b64 v18, v[106:107] offset:42112
    s_branch EXPD
    s_nop 0
EXP2:
    v_sub_u32 v18, 96560, v241
    v_cvt_pk_bf16_f32 v96, v46, v46
    v_cvt_pk_bf16_f32 v97, v45, v45
    v_cvt_pk_bf16_f32 v98, v45, v44
    v_cvt_pk_bf16_f32 v99, v44, v44
    v_cvt_pk_bf16_f32 v100, v46, v45
    v_cvt_pk_bf16_f32 v101, v45, v45
    v_cvt_pk_bf16_f32 v102, v44, v44
    v_cvt_pk_bf16_f32 v103, v44, v44
    ds_write_b128 v18, v[96:99] offset:0
    ds_write_b128 v18, v[100:103] offset:4224
    v_cvt_pk_bf16_f32 v104, v58, v58
    v_cvt_pk_bf16_f32 v105, v57, v57
    v_cvt_pk_bf16_f32 v106, v57, v56
    v_cvt_pk_bf16_f32 v107, v56, v56
    v_cvt_pk_bf16_f32 v108, v58, v57
    v_cvt_pk_bf16_f32 v109, v57, v57
    v_cvt_pk_bf16_f32 v110, v56, v56
    v_cvt_pk_bf16_f32 v111, v56, v56
    ds_write_b128 v18, v[104:107] offset:18944
    ds_write_b128 v18, v[108:111] offset:23168
    v_cvt_pk_bf16_f32 v112, v70, v70
    v_cvt_pk_bf16_f32 v113, v69, v69
    v_cvt_pk_bf16_f32 v114, v69, v68
    v_cvt_pk_bf16_f32 v115, v68, v68
    v_cvt_pk_bf16_f32 v116, v70, v69
    v_cvt_pk_bf16_f32 v117, v69, v69
    v_cvt_pk_bf16_f32 v118, v68, v68
    v_cvt_pk_bf16_f32 v119, v68, v68
    ds_write_b128 v18, v[112:115] offset:37888
    ds_write_b128 v18, v[116:119] offset:42112
    s_branch EXPD
EXP3:
    v_lshlrev_b32 v18, 5, v240
    v_sub_u32 v18, 95520, v18
    v_cvt_pk_bf16_f32 v96, v46, v46
    v_cvt_pk_bf16_f32 v97, v46, v46
    v_cvt_pk_bf16_f32 v98, v45, v45
    v_cvt_pk_bf16_f32 v99, v45, v45
    ds_write_b128 v18, v[96:99] offset:0
    v_cvt_pk_bf16_f32 v100, v45, v45
    v_cvt_pk_bf16_f32 v101, v45, v44
    v_cvt_pk_bf16_f32 v102, v44, v44
    v_cvt_pk_bf16_f32 v103, v44, v44
    ds_write_b128 v18, v[100:103] offset:16
    v_cvt_pk_bf16_f32 v104, v46, v46
    v_cvt_pk_bf16_f32 v105, v46, v45
    v_cvt_pk_bf16_f32 v106, v45, v45
    v_cvt_pk_bf16_f32 v107, v45, v45
    ds_write_b128 v18, v[104:107] offset:4224
    v_cvt_pk_bf16_f32 v108, v45, v45
    v_cvt_pk_bf16_f32 v109, v44, v44
    v_cvt_pk_bf16_f32 v110, v44, v44
    v_cvt_pk_bf16_f32 v111, v44, v44
    ds_write_b128 v18, v[108:111] offset:4240
    v_cvt_pk_bf16_f32 v112, v58, v58
    v_cvt_pk_bf16_f32 v113, v58, v58
    v_cvt_pk_bf16_f32 v114, v57, v57
    v_cvt_pk_bf16_f32 v115, v57, v57
    ds_write_b128 v18, v[112:115] offset:18944
    v_cvt_pk_bf16_f32 v116, v57, v57
    v_cvt_pk_bf16_f32 v117, v57, v56
    v_cvt_pk_bf16_f32 v118, v56, v56
    v_cvt_pk_bf16_f32 v119, v56, v56
    ds_write_b128 v18, v[116:119] offset:18960
    v_cvt_pk_bf16_f32 v120, v58, v58
    v_cvt_pk_bf16_f32 v121, v58, v57
    v_cvt_pk_bf16_f32 v122, v57, v57
    v_cvt_pk_bf16_f32 v123, v57, v57
    ds_write_b128 v18, v[120:123] offset:23168
    v_cvt_pk_bf16_f32 v124, v57, v57
    v_cvt_pk_bf16_f32 v125, v56, v56
    v_cvt_pk_bf16_f32 v126, v56, v56
    v_cvt_pk_bf16_f32 v127, v56, v56
    ds_write_b128 v18, v[124:127] offset:23184
    v_cvt_pk_bf16_f32 v128, v70, v70
    v_cvt_pk_bf16_f32 v129, v70, v70
    v_cvt_pk_bf16_f32 v130, v69, v69
    v_cvt_pk_bf16_f32 v131, v69, v69
    ds_write_b128 v18, v[128:131] offset:37888
    v_cvt_pk_bf16_f32 v132, v69, v69
    v_cvt_pk_bf16_f32 v133, v69, v68
    v_cvt_pk_bf16_f32 v134, v68, v68
    v_cvt_pk_bf16_f32 v135, v68, v68
    ds_write_b128 v18, v[132:135] offset:37904
    v_cvt_pk_bf16_f32 v136, v70, v70
    v_cvt_pk_bf16_f32 v137, v70, v69
    v_cvt_pk_bf16_f32 v138, v69, v69
    v_cvt_pk_bf16_f32 v139, v69, v69
    ds_write_b128 v18, v[136:139] offset:42112
    v_cvt_pk_bf16_f32 v140, v69, v69
    v_cvt_pk_bf16_f32 v141, v68, v68
    v_cvt_pk_bf16_f32 v142, v68, v68
    v_cvt_pk_bf16_f32 v143, v68, v68
    ds_write_b128 v18, v[140:143] offset:42128
EXPD:
    v_and_b32_e64 v24, 1, v240
    v_bfe_u32 v25, v240, 1, 3
    v_lshrrev_b32 v26, 4, v240
    s_lshl_b32 s75, s3, 7
    s_sub_u32 s76, 98168, s75
    v_mul_u32_u24 v2, 4224, v24
    v_sub_u32 v2, s76, v2
    v_lshlrev_b32 v27, 3, v25
    v_sub_u32_e64 v2, v2, v27
    v_lshl_add_u32 v2, v26, 4, v2
    s_sub_u32 s76, 89312, s75
    v_mul_u32_u24 v3, 5152, v24
    v_sub_u32_e64 v3, s76, v3
    v_lshl_add_u32 v3, v25, 6, v3
    v_lshl_add_u32 v3, v26, 4, v3
    s_lshl_b32 s76, s58, 9
    v_add_u32 v4, s76, v3
    v_subrev_u32 v4, 512, v4
    v_bfe_u32 v27, v240, 2, 1
    v_lshl_add_u32 v27, v27, 1, v24
    v_xor_b32 v27, v27, v26
    v_lshlrev_b32 v27, 4, v27
    v_lshl_add_u32 v27, v25, 6, v27
    v_lshl_add_u32 v28, v24, 12, v27
    s_lshl_b32 s77, s3, 13
    s_add_u32 s76, s77, 25600
    v_add_u32 v5, s76, v28
    s_add_u32 s76, s77, 83200
    v_add_u32_e64 v7, s76, v28
    v_lshl_add_u32 v28, v24, 11, v27
    s_lshl_b32 s77, s3, 12
    v_add_u32 v6, s77, v28
    v_bfe_u32 v27, v0, 3, 1
    v_lshlrev_b32 v27, 1, v27
    v_xor_b32 v27, v27, v0
    v_lshlrev_b32_e64 v27, 4, v27
    v_add_u32 v12, 25600, v27
    v_xor_b32_e64 v13, 16, v12
    v_add_u32 v14, 83200, v27
    v_xor_b32_e64 v15, 16, v14
    v_and_b32 v27, 511, v27
    s_lshl_b32 s77, s3, 9
    v_add_u32 v244, s77, v27
    v_xor_b32 v245, 16, v244
    v_lshlrev_b32 v247, 2, v0
    v_add_u32 v247, 83200, v247
    v_lshlrev_b32_e64 v248, 3, v0
    v_add_u32 v248, 58368, v248
    v_lshlrev_b32_e64 v249, 5, v0
    v_add_u32 v249, 58368, v249
    s_lshl_b32 s75, s62, 2
    s_add_u32 s75, s75, s3
    s_mul_i32 s76, s75, 3
    v_lshlrev_b32 v27, 1, v24
    v_add_u32 v27, s76, v27
    v_lshrrev_b32 v27, 2, v27
    v_lshrrev_b32 v28, 1, v240
    v_min_u32 v28, 19, v28
    v_mul_u32_u24_e64 v28, 48, v28
    v_add_lshl_u32 v254, v27, v28, 6
    s_mov_b32 s71, 0x70000
    s_mul_i32 s14, s75, 192
    s_add_u32 s14, s14, 0xc0000
    s_mul_i32 s13, s75, 3072
    s_add_u32 s13, s13, 0x800000
    v_lshrrev_b32 v25, 3, v240
    v_mul_u32_u24 v27, 5, v25
    v_add_u32 v30, 2, v27
    v_mul_u32_u24 v28, 5, v26
    v_and_b32 v29, 1, v25
    v_mul_u32_u24 v29, 3, v29
    v_add_u32 v31, v28, v29
    v_and_b32 v32, 7, v240
    v_and_b32 v33, 1, v26
    s_and_b32 s75, s3, 1
    s_lshl_b32 s75, s75, 1
    v_or_b32 v33, s75, v33
    v_lshlrev_b32 v33, 1, v33
    v_xor_b32 v33, v33, v32
    v_lshlrev_b32 v33, 4, v33
    s_mul_i32 s75, s3, 40
    v_add_u32_e64 v30, s75, v30
    v_lshl_add_u32 v30, v30, 12, v33
    v_accvgpr_write_b32 a240, v30
    s_mul_i32 s75, s3, 20
    v_add_u32 v31, s75, v31
    v_lshl_add_u32 v31, v31, 12, v33
    v_accvgpr_write_b32 a241, v31
    s_lshl_b32 s18, s61, 8
    s_add_u32 s18, s18, 0x500000
    s_lshl_b32 s19, s3, 10
    v_bfe_u32 v25, v240, 2, 2
    v_lshl_add_u32 v27, v26, 3, v25
    v_lshlrev_b32 v27, 7, v27
    v_and_b32 v28, 1, v26
    v_lshrrev_b32_e64 v29, 1, v25
    v_lshl_add_u32 v28, v28, 1, v29
    v_xor_b32_e64 v30, s3, v28
    v_lshl_add_u32 v30, v30, 5, v27
    v_and_b32_e64 v31, 3, v240
    v_lshl_add_u32 v30, v31, 3, v30
    v_accvgpr_write_b32 a244, v30
    v_and_b32 v25, 15, v240
    v_cmp_gt_u32 vcc, 4, v25
    v_mov_b32 v28, 0x7ffffff0
    v_mul_u32_u24 v25, 12288, v25
    v_lshl_add_u32 v25, v26, 4, v25
    v_accvgpr_write_b32 a245, v25
    v_add_u32 v25, 196608, v25
    v_cndmask_b32_e64 v25, v28, v25, vcc
    v_accvgpr_write_b32 a246, v25
    v_mul_u32_u24 v34, 6554, v240
    v_lshrrev_b32_e64 v34, 16, v34
    v_mul_u32_u24 v34, 1120, v34
    v_add_u32 v236, v34, v241
    s_lshl_b32 s75, s3, 8
    s_add_u32 s75, s75, s2
    s_lshr_b32 s72, s75, 3
    s_and_b32 s73, s75, 7
    s_lshl_b32 s30, s75, 6
    s_add_u32 s30, s30, 0x1000
    s_mul_i32 s28, s72, 40960
    s_mul_i32 s74, s73, 160
    s_add_u32 s28, s28, s74
    s_mul_i32 s29, s73, 245760
    s_mul_i32 s74, s72, 5120
    s_add_u32 s29, s29, s74
    s_add_u32 s29, s29, 0xc00000
    s_cmp_lt_u32 s75, 384
    s_cselect_b32 s29, s29, 0x7ffffff0
    s_cselect_b32 s30, s30, 0x7ffffff0
    s_mov_b32 s21, s64
    v_lshrrev_b32 v34, 4, v240
    v_bfe_u32 v35, v240, 2, 1
    v_lshl_add_u32 v34, v34, 1, v35
    v_bfe_u32 v35, v240, 3, 1
    v_lshl_add_u32 v34, v35, 3, v34
    v_mul_u32_u24 v34, 160, v34
    v_add_u32 v34, s21, v34
    v_and_b32 v35, 3, v240
    v_lshl_add_u32 v237, v35, 4, v34
    v_lshl_add_u32 v238, v35, 3, v34
    s_lshl_b32 s73, s61, 3
    s_add_u32 s73, s73, s3
    s_mul_i32 s73, s73, 49152
    s_mul_i32 s74, s62, 3072
    s_add_u32 s73, s73, s74
    s_add_u32 s24, s73, 0xe00000
    s_add_u32 s25, s73, 0xe30000
    s_mov_b32 s70, 0
RCHK:
    s_waitcnt vmcnt(12)
    v_xor_b32 v16, s56, v199
    s_waitcnt vmcnt(10)
    v_xor_b32 v18, s56, v203
    v_or_b32 v16, v16, v18
    s_waitcnt vmcnt(8)
    v_xor_b32 v18, s56, v207
    v_or_b32 v16, v16, v18
    s_waitcnt vmcnt(6)
    v_xor_b32 v18, s56, v211
    v_or_b32 v16, v16, v18
    v_xor_b32 v18, s56, v215
    v_or_b32 v16, v16, v18
    v_xor_b32 v18, s56, v219
    v_or_b32 v16, v16, v18
    v_xor_b32 v18, s56, v223
    v_or_b32 v16, v16, v18
    s_waitcnt vmcnt(5)
    v_xor_b32 v18, s56, v227
    v_or_b32 v16, v16, v18
    v_cmp_ne_u32 vcc, 0, v16
    s_cbranch_vccz RDONE
    s_add_u32 s70, s70, 1
    s_cmp_gt_u32 s70, 200000
    s_cbranch_scc1 RDONE
    s_sleep 4
    s_mov_b32 s73, s20
    s_mov_b32 s74, 0x60000
    buffer_load_dwordx4 v[196:199], v1, s[36:39], s73 offen sc1
    buffer_load_dwordx4 v[212:215], v1, s[36:39], s74 offen sc1
    s_add_u32 s73, s73, 4096
    s_add_u32 s74, s74, 4096
    buffer_load_dwordx4 v[200:203], v1, s[36:39], s73 offen sc1
    buffer_load_dwordx4 v[216:219], v1, s[36:39], s74 offen sc1
    s_add_u32 s73, s73, 4096
    s_add_u32 s74, s74, 4096
    buffer_load_dwordx4 v[204:207], v1, s[36:39], s73 offen sc1
    buffer_load_dwordx4 v[220:223], v1, s[36:39], s74 offen sc1
    s_add_u32 s73, s73, 4096
    s_add_u32 s74, s74, 4096
    buffer_load_dwordx4 v[208:211], v1, s[36:39], s73 offen sc1
    buffer_load_dwordx4 v[224:227], v1, s[36:39], s74 offen sc1
    s_waitcnt vmcnt(0)
    s_branch RCHK
RDONE:
    v_and_b32 v215, 0xffff0000, v214
    v_lshlrev_b32_e64 v214, 16, v214
    v_and_b32 v219, 0xffff0000, v218
    v_lshlrev_b32_e64 v218, 16, v218
    v_and_b32 v223, 0xffff0000, v222
    v_lshlrev_b32_e64 v222, 16, v222
    v_and_b32 v227, 0xffff0000, v226
    v_lshlrev_b32_e64 v226, 16, v226
    v_pk_mul_f32 v[214:215], v[214:215], v[212:213] neg_lo:[1,0] neg_hi:[1,0]
    v_pk_mul_f32 v[218:219], v[218:219], v[216:217] neg_lo:[1,0] neg_hi:[1,0]
    v_pk_mul_f32 v[222:223], v[222:223], v[220:221] neg_lo:[1,0] neg_hi:[1,0]
    v_pk_mul_f32 v[226:227], v[226:227], v[224:225] neg_lo:[1,0] neg_hi:[1,0]
    v_lshlrev_b32_e64 v40, 16, v196
    v_and_b32 v41, 0xffff0000, v196
    v_lshlrev_b32_e64 v42, 16, v200
    v_and_b32 v43, 0xffff0000, v200
    v_lshlrev_b32_e64 v44, 16, v204
    v_and_b32 v45, 0xffff0000, v204
    v_lshlrev_b32_e64 v46, 16, v208
    v_and_b32 v47, 0xffff0000, v208
    v_pk_fma_f32 v[64:65], v[40:41], v[212:213], v[214:215]
    v_pk_fma_f32 v[66:67], v[42:43], v[216:217], v[218:219]
    v_pk_fma_f32 v[68:69], v[44:45], v[220:221], v[222:223]
    v_pk_fma_f32 v[70:71], v[46:47], v[224:225], v[226:227]
    v_cvt_pk_bf16_f32 v80, v64, v65
    v_cvt_pk_bf16_f32 v81, v66, v67
    v_cvt_pk_bf16_f32 v82, v68, v69
    v_cvt_pk_bf16_f32 v83, v70, v71
    v_pk_fma_f32 v[40:41], v[64:65], s[22:23], v[40:41]
    v_pk_fma_f32 v[42:43], v[66:67], s[22:23], v[42:43]
    v_pk_fma_f32 v[44:45], v[68:69], s[22:23], v[44:45]
    v_pk_fma_f32 v[46:47], v[70:71], s[22:23], v[46:47]
    ds_write2st64_b32 v247, v80, v81 offset0:4 offset1:8
    ds_write2st64_b32 v247, v82, v83 offset0:12 offset1:16
    ds_write_b32 v247, v80 offset:6180
    ds_write_b32 v247, v81 offset:7204
    ds_write_b32 v247, v82 offset:8228
    ds_write_b32 v247, v83 offset:9252
    ds_write2st64_b64 v248, v[40:41], v[42:43] offset0:0 offset1:4
    ds_write2st64_b64 v248, v[44:45], v[46:47] offset0:8 offset1:12
    v_lshlrev_b32_e64 v48, 16, v197
    v_and_b32 v49, 0xffff0000, v197
    v_lshlrev_b32_e64 v50, 16, v201
    v_and_b32 v51, 0xffff0000, v201
    v_lshlrev_b32_e64 v52, 16, v205
    v_and_b32 v53, 0xffff0000, v205
    v_lshlrev_b32_e64 v54, 16, v209
    v_and_b32 v55, 0xffff0000, v209
    v_pk_fma_f32 v[72:73], v[48:49], v[212:213], v[214:215]
    v_pk_fma_f32 v[74:75], v[50:51], v[216:217], v[218:219]
    v_pk_fma_f32 v[76:77], v[52:53], v[220:221], v[222:223]
    v_pk_fma_f32 v[78:79], v[54:55], v[224:225], v[226:227]
    v_cvt_pk_bf16_f32 v84, v72, v73
    v_cvt_pk_bf16_f32 v85, v74, v75
    v_cvt_pk_bf16_f32 v86, v76, v77
    v_cvt_pk_bf16_f32 v87, v78, v79
    v_pk_fma_f32 v[48:49], v[72:73], s[66:67], v[48:49]
    v_pk_fma_f32 v[50:51], v[74:75], s[66:67], v[50:51]
    v_pk_fma_f32 v[52:53], v[76:77], s[66:67], v[52:53]
    v_pk_fma_f32 v[54:55], v[78:79], s[66:67], v[54:55]
    ds_write2st64_b32 v247, v84, v85 offset0:78 offset1:82
    ds_write2st64_b32 v247, v86, v87 offset0:86 offset1:90
    ds_write_b32 v247, v84 offset:25124
    ds_write_b32 v247, v85 offset:26148
    ds_write_b32 v247, v86 offset:27172
    ds_write_b32 v247, v87 offset:28196
    ds_write2st64_b64 v248, v[48:49], v[50:51] offset0:16 offset1:20
    ds_write2st64_b64 v248, v[52:53], v[54:55] offset0:24 offset1:28
    v_lshlrev_b32_e64 v56, 16, v198
    v_and_b32 v57, 0xffff0000, v198
    v_lshlrev_b32_e64 v58, 16, v202
    v_and_b32 v59, 0xffff0000, v202
    v_lshlrev_b32_e64 v60, 16, v206
    v_and_b32 v61, 0xffff0000, v206
    v_lshlrev_b32_e64 v62, 16, v210
    v_and_b32 v63, 0xffff0000, v210
    v_pk_fma_f32 v[64:65], v[56:57], v[212:213], v[214:215]
    v_pk_fma_f32 v[66:67], v[58:59], v[216:217], v[218:219]
    v_pk_fma_f32 v[68:69], v[60:61], v[220:221], v[222:223]
    v_pk_fma_f32 v[70:71], v[62:63], v[224:225], v[226:227]
    v_cvt_pk_bf16_f32 v88, v64, v65
    v_cvt_pk_bf16_f32 v89, v66, v67
    v_cvt_pk_bf16_f32 v90, v68, v69
    v_cvt_pk_bf16_f32 v91, v70, v71
    v_pk_fma_f32 v[56:57], v[64:65], s[68:69], v[56:57]
    v_pk_fma_f32 v[58:59], v[66:67], s[68:69], v[58:59]
    v_pk_fma_f32 v[60:61], v[68:69], s[68:69], v[60:61]
    v_pk_fma_f32 v[62:63], v[70:71], s[68:69], v[62:63]
    ds_write2st64_b32 v247, v88, v89 offset0:152 offset1:156
    ds_write2st64_b32 v247, v90, v91 offset0:160 offset1:164
    ds_write_b32 v247, v88 offset:44068
    ds_write_b32 v247, v89 offset:45092
    ds_write_b32 v247, v90 offset:46116
    ds_write_b32 v247, v91 offset:47140
    ds_write2st64_b64 v248, v[56:57], v[58:59] offset0:32 offset1:36
    ds_write2st64_b64 v248, v[60:61], v[62:63] offset0:40 offset1:44
    s_waitcnt lgkmcnt(0)
    s_barrier
    ds_read_b64 v[120:121], v2 offset:3648
    ds_read_b64 v[122:123], v2 offset:3656
    ds_read_b128 v[124:127], v4 offset:64
    ds_read_b64 v[128:129], v2 offset:3136
    ds_read_b64 v[130:131], v2 offset:3144
    ds_read_b128 v[132:135], v4 offset:576
    ds_read_b64 v[136:137], v2 offset:2624
    ds_read_b64 v[138:139], v2 offset:2632
    ds_read_b128 v[140:143], v4 offset:1088
    ds_read_b64 v[144:145], v2 offset:2112
    ds_read_b64 v[146:147], v2 offset:2120
    ds_read_b128 v[148:151], v4 offset:1600
    ds_read_b64 v[152:153], v2 offset:1600
    ds_read_b64 v[154:155], v2 offset:1608
    ds_read_b128 v[156:159], v4 offset:2112
    v_and_b32 v8, 15, v240
    v_mov_b32 v9, s65
    s_waitcnt vmcnt(1)
    s_nop 0
    ds_read_b64_tr_b16 v[80:81], v230
    ds_read_b64_tr_b16 v[82:83], v230 offset:256
    ds_read_b64_tr_b16 v[84:85], v231
    ds_read_b64_tr_b16 v[86:87], v231 offset:256
    ds_read_b64_tr_b16 v[88:89], v232
    ds_read_b64_tr_b16 v[90:91], v232 offset:256
    ds_read_b64_tr_b16 v[92:93], v233
    ds_read_b64_tr_b16 v[94:95], v233 offset:256
    v_cmp_eq_u32 vcc, 0, v8
    s_nop 1
    v_cndmask_b32 v100, 0, v9, vcc
    v_cndmask_b32 v101, 0, v9, vcc
    v_cndmask_b32 v102, 0, v9, vcc
    v_cndmask_b32 v103, 0, v9, vcc
    v_cmp_eq_u32 vcc, 1, v8
    s_nop 1
    v_cndmask_b32 v104, 0, v9, vcc
    v_cndmask_b32 v105, 0, v9, vcc
    v_cndmask_b32 v106, 0, v9, vcc
    v_cndmask_b32 v107, 0, v9, vcc
    v_cmp_eq_u32 vcc, 2, v8
    s_nop 1
    v_cndmask_b32 v108, 0, v9, vcc
    v_cndmask_b32 v109, 0, v9, vcc
    v_cndmask_b32 v110, 0, v9, vcc
    v_cndmask_b32 v111, 0, v9, vcc
    v_cmp_eq_u32 vcc, 3, v8
    s_nop 1
    v_cndmask_b32 v112, 0, v9, vcc
    v_cndmask_b32 v113, 0, v9, vcc
    v_cndmask_b32 v114, 0, v9, vcc
    v_cndmask_b32 v115, 0, v9, vcc
    s_waitcnt lgkmcnt(6)
    v_mfma_f32_16x16x32_bf16 v[96:99], v[80:83], v[100:103], 0
    s_waitcnt lgkmcnt(4)
    v_mfma_f32_16x16x32_bf16 v[96:99], v[84:87], v[104:107], v[96:99]
    s_waitcnt lgkmcnt(2)
    v_mfma_f32_16x16x32_bf16 v[96:99], v[88:91], v[108:111], v[96:99]
    s_waitcnt lgkmcnt(0)
    v_mfma_f32_16x16x32_bf16 v[96:99], v[92:95], v[112:115], v[96:99]
    v_mfma_f32_16x16x32_bf16 v[16:19], v[128:131], v[124:127], 0
    buffer_store_dwordx4 v[80:83], v234, s[36:39], s6 offen offset:0 sc1
    ds_read_b64 v[160:161], v2 offset:1088
    v_mfma_f32_16x16x32_bf16 v[16:19], v[120:123], v[132:135], v[16:19]
    ds_read_b64 v[162:163], v2 offset:1096
    v_mfma_f32_16x16x32_bf16 v[20:23], v[136:139], v[132:135], 0
    ds_read_b128 v[164:167], v4 offset:2624
    v_mfma_f32_16x16x32_bf16 v[20:23], v[128:131], v[140:143], v[20:23]
    ds_read_b64 v[168:169], v2 offset:576
    v_mfma_f32_16x16x32_bf16 v[20:23], v[144:147], v[124:127], v[20:23]
    ds_read_b64 v[170:171], v2 offset:584
    ds_read_b128 v[172:175], v4 offset:3136
    v_mfma_f32_16x16x32_bf16 v[20:23], v[120:123], v[148:151], v[20:23]
    ds_read_b64 v[176:177], v2 offset:64
    v_mfma_f32_16x16x32_bf16 v[24:27], v[144:147], v[140:143], 0
    ds_read_b64 v[178:179], v2 offset:72
    v_mfma_f32_16x16x32_bf16 v[24:27], v[136:139], v[148:151], v[24:27]
    ds_read_b128 v[180:183], v4 offset:3648
    v_mfma_f32_16x16x32_bf16 v[24:27], v[152:155], v[132:135], v[24:27]
    buffer_store_dwordx4 v[84:87], v234, s[36:39], s6 offen offset:1024 sc1
    ds_read_b64 v[184:185], v2 offset:3584
    v_mfma_f32_16x16x32_bf16 v[24:27], v[128:131], v[156:159], v[24:27]
    ds_read_b64 v[186:187], v2 offset:3592
    v_mfma_f32_16x16x32_bf16 v[28:31], v[152:155], v[148:151], 0
    ds_read_b128 v[188:191], v4 offset:0
    v_mfma_f32_16x16x32_bf16 v[28:31], v[144:147], v[156:159], v[28:31]
    ds_read_b64 v[192:193], v2 offset:3072
    s_waitcnt lgkmcnt(10)
    s_nop 0
    v_mfma_f32_16x16x32_bf16 v[24:27], v[160:163], v[124:127], v[24:27]
    ds_read_b64 v[194:195], v2 offset:3080
    v_mfma_f32_16x16x32_bf16 v[24:27], v[120:123], v[164:167], v[24:27]
    ds_read_b128 v[196:199], v4 offset:512
    v_mfma_f32_16x16x32_bf16 v[28:31], v[160:163], v[140:143], v[28:31]
    ds_read_b64 v[200:201], v2 offset:2560
    v_mfma_f32_16x16x32_bf16 v[28:31], v[136:139], v[164:167], v[28:31]
    ds_read_b64 v[202:203], v2 offset:2568
    s_waitcnt lgkmcnt(11)
    v_mfma_f32_16x16x32_bf16 v[28:31], v[168:171], v[132:135], v[28:31]
    buffer_store_dwordx4 v[88:91], v234, s[36:39], s6 offen offset:2048 sc1
    ds_read_b128 v[204:207], v4 offset:1024
    v_mfma_f32_16x16x32_bf16 v[28:31], v[128:131], v[172:175], v[28:31]
    ds_read_b64 v[208:209], v2 offset:2048
    s_waitcnt lgkmcnt(10)
    v_mfma_f32_16x16x32_bf16 v[28:31], v[176:179], v[124:127], v[28:31]
    ds_read_b64 v[210:211], v2 offset:2056
    v_mfma_f32_16x16x32_bf16 v[28:31], v[120:123], v[180:183], v[28:31]
    ds_read_b128 v[212:215], v4 offset:1536
    s_waitcnt lgkmcnt(6)
    v_mfma_f32_16x16x32_bf16 v[16:19], v[192:195], v[188:191], v[16:19]
    ds_read_b64 v[216:217], v2 offset:1536
    ds_read_b64 v[218:219], v2 offset:1544
    v_mfma_f32_16x16x32_bf16 v[16:19], v[184:187], v[196:199], v[16:19]
    ds_read_b128 v[220:223], v4 offset:2048
    s_waitcnt lgkmcnt(6)
    v_mfma_f32_16x16x32_bf16 v[20:23], v[200:203], v[196:199], v[20:23]
    ds_read_b64 v[224:225], v2 offset:1024
    ds_read_b64 v[226:227], v2 offset:1032
    v_mfma_f32_16x16x32_bf16 v[20:23], v[192:195], v[204:207], v[20:23]
    ds_read_b128 v[144:147], v4 offset:2560
    s_waitcnt lgkmcnt(6)
    s_nop 0
    v_mfma_f32_16x16x32_bf16 v[20:23], v[208:211], v[188:191], v[20:23]
    buffer_store_dwordx4 v[92:95], v234, s[36:39], s6 offen offset:3072 sc1
    ds_read_b64 v[148:149], v2 offset:512
    v_mfma_f32_16x16x32_bf16 v[20:23], v[184:187], v[212:215], v[20:23]
    ds_read_b64 v[150:151], v2 offset:520
    ds_read_b128 v[152:155], v4 offset:3072
    v_mfma_f32_16x16x32_bf16 v[24:27], v[208:211], v[204:207], v[24:27]
    ds_read_b64 v[156:157], v2 offset:0
    v_mfma_f32_16x16x32_bf16 v[24:27], v[200:203], v[212:215], v[24:27]
    ds_read_b64 v[158:159], v2 offset:8
    s_waitcnt lgkmcnt(8)
    s_nop 0
    v_mfma_f32_16x16x32_bf16 v[24:27], v[216:219], v[196:199], v[24:27]
    ds_read_b128 v[136:139], v4 offset:3584
    v_mfma_f32_16x16x32_bf16 v[24:27], v[192:195], v[220:223], v[24:27]
    ds_read_b64 v[140:141], v2 offset:22592
    v_mfma_f32_16x16x32_bf16 v[28:31], v[216:219], v[212:215], v[28:31]
    ds_read_b64 v[142:143], v2 offset:22600
    v_mfma_f32_16x16x32_bf16 v[28:31], v[208:211], v[220:223], v[28:31]
    ds_read_b128 v[160:163], v3 offset:19008
    s_waitcnt lgkmcnt(9)
    s_nop 0
    v_mfma_f32_16x16x32_bf16 v[24:27], v[224:227], v[188:191], v[24:27]
    buffer_store_dwordx2 v[96:97], v235, s[36:39], s7 offen sc1
    buffer_store_dwordx2 v[98:99], v235, s[36:39], s7 offen offset:16 sc1
    ds_read_b64 v[164:165], v2 offset:22080
    v_mfma_f32_16x16x32_bf16 v[24:27], v[184:187], v[144:147], v[24:27]
    ds_read_b64 v[166:167], v2 offset:22088
    v_mfma_f32_16x16x32_bf16 v[28:31], v[224:227], v[204:207], v[28:31]
    ds_read_b128 v[128:131], v3 offset:19520
    v_mfma_f32_16x16x32_bf16 v[28:31], v[200:203], v[144:147], v[28:31]
    ds_read_b64 v[132:133], v2 offset:21568
    s_waitcnt lgkmcnt(10)
    v_mfma_f32_16x16x32_bf16 v[28:31], v[148:151], v[196:199], v[28:31]
    ds_read_b64 v[134:135], v2 offset:21576
    v_mfma_f32_16x16x32_bf16 v[28:31], v[192:195], v[152:155], v[28:31]
    ds_read_b128 v[168:171], v3 offset:20032
    s_waitcnt lgkmcnt(9)
    v_mfma_f32_16x16x32_bf16 v[28:31], v[156:159], v[188:191], v[28:31]
    ds_read_b64 v[172:173], v2 offset:21056
    v_mfma_f32_16x16x32_bf16 v[28:31], v[184:187], v[136:139], v[28:31]
    ds_read_b64 v[174:175], v2 offset:21064
    ds_write_b128 v6, v[16:19] offset:0
    ds_write_b128 v6, v[20:23] offset:512
    ds_write_b128 v6, v[24:27] offset:1024
    s_nop 3
    ds_write_b128 v6, v[28:31] offset:1536
    s_waitcnt lgkmcnt(12)
    v_mfma_f32_16x16x32_bf16 v[48:51], v[140:143], v[160:163], 0
    s_add_u32 m0, s21, 0
    s_add_u32 s75, s28, 0
    buffer_load_dwordx4 v236, s[40:43], s75 offen lds
    s_waitcnt lgkmcnt(9)
    s_nop 0
    v_mfma_f32_16x16x32_bf16 v[52:55], v[164:167], v[160:163], 0
    ds_read_b128 v[120:123], v3 offset:20544
    ds_read_b64 v[124:125], v2 offset:20544
    v_mfma_f32_16x16x32_bf16 v[52:55], v[140:143], v[128:131], v[52:55]
    ds_read_b64 v[126:127], v2 offset:20552
    ds_read_b128 v[176:179], v3 offset:21056
    v_mfma_f32_16x16x32_bf16 v[56:59], v[164:167], v[128:131], 0
    ds_read_b64 v[180:181], v2 offset:20032
    s_waitcnt lgkmcnt(11)
    v_mfma_f32_16x16x32_bf16 v[56:59], v[132:135], v[160:163], v[56:59]
    ds_read_b64 v[182:183], v2 offset:20040
    ds_read_b128 v[208:211], v3 offset:21568
    v_mfma_f32_16x16x32_bf16 v[56:59], v[140:143], v[168:171], v[56:59]
    ds_read_b64 v[212:213], v2 offset:19520
    s_waitcnt lgkmcnt(8)
    s_barrier
    s_nop 0
    v_mfma_f32_16x16x32_bf16 v[60:63], v[132:135], v[128:131], 0
    s_add_u32 m0, s21, 960
    s_add_u32 s75, s28, 7680
    buffer_load_dwordx4 v236, s[40:43], s75 offen lds
    ds_read_b64 v[214:215], v2 offset:19528
    v_mfma_f32_16x16x32_bf16 v[60:63], v[164:167], v[168:171], v[60:63]
    ds_read_b128 v[216:219], v3 offset:22080
    ds_read_b128 v[80:83], v249 offset:0
    v_mfma_f32_16x16x32_bf16 v[64:67], v[132:135], v[168:171], 0
    ds_read_b64 v[220:221], v2 offset:19008
    s_waitcnt lgkmcnt(11)
    s_nop 0
    v_mfma_f32_16x16x32_bf16 v[60:63], v[172:175], v[160:163], v[60:63]
    ds_read_b64 v[222:223], v2 offset:19016
    ds_read_b128 v[84:87], v249 offset:16
    v_mfma_f32_16x16x32_bf16 v[60:63], v[140:143], v[120:123], v[60:63]
    ds_read_b128 v[200:203], v3 offset:22592
    ds_read_b128 v[88:91], v244 offset:0
    v_mfma_f32_16x16x32_bf16 v[64:67], v[172:175], v[128:131], v[64:67]
    ds_read_b64 v[204:205], v2 offset:22528
    ds_read_b128 v[92:95], v245 offset:2048
    v_mfma_f32_16x16x32_bf16 v[64:67], v[164:167], v[120:123], v[64:67]
    s_add_u32 m0, s21, 1920
    s_add_u32 s75, s28, 15360
    buffer_load_dwordx4 v236, s[40:43], s75 offen lds
    ds_read_b64 v[206:207], v2 offset:22536
    v_mfma_f32_16x16x32_bf16 v[68:71], v[172:175], v[168:171], 0
    ds_read_b128 v[224:227], v3 offset:18944
    ds_read_b128 v[96:99], v244 offset:4096
    v_mfma_f32_16x16x32_bf16 v[68:71], v[132:135], v[120:123], v[68:71]
    ds_read_b128 v[100:103], v245 offset:6144
    ds_read_b128 v[104:107], v244 offset:8192
    v_mfma_f32_16x16x32_bf16 v[72:75], v[172:175], v[120:123], 0
    ds_read_b128 v[108:111], v245 offset:10240
    s_waitcnt lgkmcnt(15)
    s_nop 0
    v_mfma_f32_16x16x32_bf16 v[64:67], v[124:127], v[160:163], v[64:67]
    ds_read_b64 v[144:145], v2 offset:22016
    ds_read_b128 v[112:115], v244 offset:12288
    v_mfma_f32_16x16x32_bf16 v[64:67], v[140:143], v[176:179], v[64:67]
    ds_read_b64 v[146:147], v2 offset:22024
    ds_read_b128 v[116:119], v245 offset:14336
    v_mfma_f32_16x16x32_bf16 v[68:71], v[124:127], v[128:131], v[68:71]
    s_add_u32 m0, s21, 2880
    s_add_u32 s75, s28, 23040
    buffer_load_dwordx4 v236, s[40:43], s75 offen lds
    ds_read_b128 v[192:195], v3 offset:19456
    v_mfma_f32_16x16x32_bf16 v[68:71], v[164:167], v[176:179], v[68:71]
    s_waitcnt lgkmcnt(11)
    v_add_f32 v80, v80, v88
    v_add_f32_e64 v81, v81, v89
    v_mfma_f32_16x16x32_bf16 v[72:75], v[124:127], v[168:171], v[72:75]
    v_add_f32 v82, v82, v92
    v_add_f32 v83, v83, v93
    v_mfma_f32_16x16x32_bf16 v[72:75], v[132:135], v[176:179], v[72:75]
    v_add_f32 v84, v84, v90
    v_add_f32 v85, v85, v91
    v_mfma_f32_16x16x32_bf16 v[76:79], v[124:127], v[120:123], 0
    v_add_f32 v86, v86, v94
    v_add_f32 v87, v87, v95
    v_mfma_f32_16x16x32_bf16 v[76:79], v[172:175], v[176:179], v[76:79]
    s_waitcnt lgkmcnt(7)
    v_add_f32 v80, v80, v96
    v_mfma_f32_16x16x32_bf16 v[68:71], v[180:183], v[160:163], v[68:71]
    s_add_u32 m0, s21, 3840
    s_add_u32 s75, s28, 30720
    buffer_load_dwordx4 v236, s[40:43], s75 offen lds
    ds_read_b64 v[196:197], v2 offset:21504
    v_mfma_f32_16x16x32_bf16 v[68:71], v[140:143], v[208:211], v[68:71]
    ds_read_b64 v[198:199], v2 offset:21512
    v_add_f32_e64 v81, v81, v97
    v_mfma_f32_16x16x32_bf16 v[72:75], v[180:183], v[128:131], v[72:75]
    ds_read_b128 v[148:151], v3 offset:19968
    v_add_f32_e64 v82, v82, v100
    v_mfma_f32_16x16x32_bf16 v[72:75], v[164:167], v[208:211], v[72:75]
    v_add_f32 v83, v83, v101
    v_add_f32 v84, v84, v98
    v_mfma_f32_16x16x32_bf16 v[76:79], v[180:183], v[168:171], v[76:79]
    v_add_f32 v85, v85, v99
    v_add_f32 v86, v86, v102
    v_mfma_f32_16x16x32_bf16 v[76:79], v[132:135], v[208:211], v[76:79]
    v_add_f32_e64 v87, v87, v103
    v_mfma_f32_16x16x32_bf16 v[72:75], v[212:215], v[160:163], v[72:75]
    s_add_u32 m0, s21, 4800
    s_add_u32 s75, s28, 38400
    buffer_load_dwordx4 v236, s[40:43], s75 offen lds
    ds_read_b64 v[152:153], v2 offset:20992
    v_mfma_f32_16x16x32_bf16 v[72:75], v[140:143], v[216:219], v[72:75]
    ds_read_b64 v[154:155], v2 offset:21000
    s_waitcnt lgkmcnt(10)
    v_add_f32 v80, v80, v104
    v_mfma_f32_16x16x32_bf16 v[76:79], v[212:215], v[128:131], v[76:79]
    ds_read_b128 v[184:187], v3 offset:20480
    v_add_f32_e64 v81, v81, v105
    v_mfma_f32_16x16x32_bf16 v[76:79], v[164:167], v[216:219], v[76:79]
    v_add_f32_e64 v82, v82, v108
    v_mfma_f32_16x16x32_bf16 v[76:79], v[220:223], v[160:163], v[76:79]
    ds_read_b64 v[188:189], v2 offset:20480
    v_add_f32_e64 v83, v83, v109
    v_mfma_f32_16x16x32_bf16 v[76:79], v[140:143], v[200:203], v[76:79]
    ds_read_b64 v[190:191], v2 offset:20488
    v_mfma_f32_16x16x32_bf16 v[48:51], v[204:207], v[224:227], v[48:51]
    ds_read_b128 v[156:159], v3 offset:20992
    s_waitcnt lgkmcnt(9)
    v_mfma_f32_16x16x32_bf16 v[52:55], v[144:147], v[224:227], v[52:55]
    ds_read_b64 v[136:137], v2 offset:19968
    v_add_f32 v84, v84, v106
    v_mfma_f32_16x16x32_bf16 v[52:55], v[204:207], v[192:195], v[52:55]
    ds_read_b64 v[138:139], v2 offset:19976
    v_add_f32_e64 v85, v85, v107
    v_mfma_f32_16x16x32_bf16 v[56:59], v[144:147], v[192:195], v[56:59]
    ds_read_b128 v[172:175], v3 offset:21504
    s_waitcnt lgkmcnt(9)
    v_mfma_f32_16x16x32_bf16 v[56:59], v[196:199], v[224:227], v[56:59]
    ds_read_b64 v[120:121], v2 offset:19456
    v_add_f32 v86, v86, v110
    v_mfma_f32_16x16x32_bf16 v[56:59], v[204:207], v[148:151], v[56:59]
    ds_read_b64 v[122:123], v2 offset:19464
    v_add_f32_e64 v87, v87, v111
    v_mfma_f32_16x16x32_bf16 v[60:63], v[196:199], v[192:195], v[60:63]
    ds_read_b128 v[124:127], v3 offset:22016
    v_add_f32_e64 v80, v80, v112
    v_mfma_f32_16x16x32_bf16 v[60:63], v[144:147], v[148:151], v[60:63]
    ds_read_b64 v[176:177], v2 offset:18944
    v_add_f32_e64 v81, v81, v113
    v_mfma_f32_16x16x32_bf16 v[64:67], v[196:199], v[148:151], v[64:67]
    ds_read_b64 v[178:179], v2 offset:18952
    s_waitcnt lgkmcnt(11)
    v_mfma_f32_16x16x32_bf16 v[60:63], v[152:155], v[224:227], v[60:63]
    ds_read_b128 v[132:135], v3 offset:22528
    v_add_f32 v82, v82, v116
    v_mfma_f32_16x16x32_bf16 v[60:63], v[204:207], v[184:187], v[60:63]
    ds_read_b64 v[168:169], v2 offset:41536
    v_add_f32_e64 v83, v83, v117
    v_mfma_f32_16x16x32_bf16 v[64:67], v[152:155], v[192:195], v[64:67]
    ds_read_b64 v[170:171], v2 offset:41544
    v_add_f32_e64 v84, v84, v114
    v_mfma_f32_16x16x32_bf16 v[64:67], v[144:147], v[184:187], v[64:67]
    ds_read_b128 v[180:183], v3 offset:37952
    v_add_f32_e64 v85, v85, v115
    v_mfma_f32_16x16x32_bf16 v[68:71], v[152:155], v[148:151], v[68:71]
    v_add_f32 v86, v86, v118
    v_add_f32 v87, v87, v119
    v_mfma_f32_16x16x32_bf16 v[68:71], v[196:199], v[184:187], v[68:71]
    v_cvt_pk_bf16_f32 v88, v80, v81
    v_cvt_pk_bf16_f32 v89, v82, v83
    v_mfma_f32_16x16x32_bf16 v[72:75], v[152:155], v[184:187], v[72:75]
    v_cvt_pk_bf16_f32 v90, v84, v85
    s_waitcnt lgkmcnt(12)
    v_mfma_f32_16x16x32_bf16 v[64:67], v[188:191], v[224:227], v[64:67]
    ds_read_b64 v[208:209], v2 offset:41024
    v_cvt_pk_bf16_f32 v91, v86, v87
    v_mfma_f32_16x16x32_bf16 v[64:67], v[204:207], v[156:159], v[64:67]
    ds_read_b64 v[210:211], v2 offset:41032
    v_min_u32 v88, -2, v88
    v_mfma_f32_16x16x32_bf16 v[68:71], v[188:191], v[192:195], v[68:71]
    ds_read_b128 v[164:167], v3 offset:38464
    buffer_store_dwordx4 v[88:91], v246, s[36:39], s10 offen sc1
    v_mfma_f32_16x16x32_bf16 v[68:71], v[144:147], v[156:159], v[68:71]
    s_waitcnt vmcnt(7)
    buffer_store_dword v243, v242, s[36:39], s8 offen sc1
    v_mfma_f32_16x16x32_bf16 v[72:75], v[188:191], v[148:151], v[72:75]
    v_mfma_f32_16x16x32_bf16 v[72:75], v[196:199], v[156:159], v[72:75]
    v_mfma_f32_16x16x32_bf16 v[76:79], v[188:191], v[184:187], v[76:79]
    v_mfma_f32_16x16x32_bf16 v[76:79], v[152:155], v[156:159], v[76:79]
    s_waitcnt lgkmcnt(12)
    v_mfma_f32_16x16x32_bf16 v[68:71], v[136:139], v[224:227], v[68:71]
    ds_read_b64 v[128:129], v2 offset:40512
    v_mfma_f32_16x16x32_bf16 v[68:71], v[204:207], v[172:175], v[68:71]
    ds_read_b64 v[130:131], v2 offset:40520
    v_mfma_f32_16x16x32_bf16 v[72:75], v[136:139], v[192:195], v[72:75]
    ds_read_b128 v[212:215], v3 offset:38976
    v_mfma_f32_16x16x32_bf16 v[72:75], v[144:147], v[172:175], v[72:75]
    v_mfma_f32_16x16x32_bf16 v[76:79], v[136:139], v[148:151], v[76:79]
    v_mfma_f32_16x16x32_bf16 v[76:79], v[196:199], v[172:175], v[76:79]
    s_waitcnt lgkmcnt(12)
    v_mfma_f32_16x16x32_bf16 v[72:75], v[120:123], v[224:227], v[72:75]
    ds_read_b64 v[216:217], v2 offset:40000
    v_mfma_f32_16x16x32_bf16 v[72:75], v[204:207], v[124:127], v[72:75]
    ds_read_b64 v[218:219], v2 offset:40008
    v_mfma_f32_16x16x32_bf16 v[76:79], v[120:123], v[192:195], v[76:79]
    ds_read_b128 v[140:143], v3 offset:39488
    v_mfma_f32_16x16x32_bf16 v[76:79], v[144:147], v[124:127], v[76:79]
    s_waitcnt lgkmcnt(12)
    v_mfma_f32_16x16x32_bf16 v[76:79], v[176:179], v[224:227], v[76:79]
    ds_read_b64 v[160:161], v2 offset:39488
    v_mfma_f32_16x16x32_bf16 v[76:79], v[204:207], v[132:135], v[76:79]
    ds_read_b64 v[162:163], v2 offset:39496
    ds_write_b128 v5, v[48:51] offset:0
    ds_write_b128 v5, v[52:55] offset:512
    ds_write_b128 v5, v[56:59] offset:1024
    ds_write_b128 v5, v[60:63] offset:1536
    ds_write_b128 v5, v[64:67] offset:2048
    ds_write_b128 v5, v[68:71] offset:2560
    ds_write_b128 v5, v[72:75] offset:3072
    ds_write_b128 v5, v[76:79] offset:3584
    s_waitcnt lgkmcnt(15)
    v_mfma_f32_16x16x32_bf16 v[16:19], v[168:171], v[180:183], 0
    ds_read_b128 v[220:223], v3 offset:40000
    v_mfma_f32_16x16x32_bf16 v[20:23], v[208:211], v[180:183], 0
    ds_read_b64 v[200:201], v2 offset:38976
    v_mfma_f32_16x16x32_bf16 v[20:23], v[168:171], v[164:167], v[20:23]
    ds_read_b64 v[202:203], v2 offset:38984
    s_waitcnt lgkmcnt(3)
    s_barrier
    s_nop 0
    v_mfma_f32_16x16x32_bf16 v[24:27], v[208:211], v[164:167], 0
    ds_read_b128 v[152:155], v3 offset:40512
    v_mfma_f32_16x16x32_bf16 v[24:27], v[128:131], v[180:183], v[24:27]
    ds_read_b64 v[184:185], v2 offset:38464
    ds_read_b128 v[80:83], v249 offset:8192
    v_mfma_f32_16x16x32_bf16 v[24:27], v[168:171], v[212:215], v[24:27]
    ds_read_b64 v[186:187], v2 offset:38472
    ds_read_b128 v[84:87], v249 offset:8208
    v_mfma_f32_16x16x32_bf16 v[28:31], v[128:131], v[164:167], 0
    ds_read_b128 v[188:191], v3 offset:41024
    ds_read_b128 v[88:91], v12 offset:0
    v_mfma_f32_16x16x32_bf16 v[28:31], v[208:211], v[212:215], v[28:31]
    ds_read_b64 v[156:157], v2 offset:37952
    ds_read_b128 v[92:95], v13 offset:4096
    v_mfma_f32_16x16x32_bf16 v[32:35], v[128:131], v[212:215], 0
    ds_read_b64 v[158:159], v2 offset:37960
    v_mfma_f32_16x16x32_bf16 v[28:31], v[216:219], v[180:183], v[28:31]
    ds_read_b128 v[196:199], v3 offset:41536
    ds_read_b128 v[96:99], v12 offset:8192
    v_mfma_f32_16x16x32_bf16 v[28:31], v[168:171], v[140:143], v[28:31]
    ds_read_b64 v[148:149], v2 offset:41472
    ds_read_b128 v[100:103], v13 offset:12288
    v_mfma_f32_16x16x32_bf16 v[32:35], v[216:219], v[164:167], v[32:35]
    ds_read_b64 v[150:151], v2 offset:41480
    ds_read_b128 v[104:107], v12 offset:16384
    v_mfma_f32_16x16x32_bf16 v[32:35], v[208:211], v[140:143], v[32:35]
    ds_read_b128 v[136:139], v3 offset:37888
    ds_read_b128 v[108:111], v13 offset:20480
    v_mfma_f32_16x16x32_bf16 v[36:39], v[216:219], v[212:215], 0
    ds_read_b128 v[112:115], v12 offset:24576
    ds_read_b128 v[116:119], v13 offset:28672
    v_mfma_f32_16x16x32_bf16 v[36:39], v[128:131], v[140:143], v[36:39]
    s_waitcnt lgkmcnt(11)
    v_add_f32 v80, v80, v88
    v_add_f32_e64 v81, v81, v89
    v_mfma_f32_16x16x32_bf16 v[40:43], v[216:219], v[140:143], 0
    v_add_f32_e64 v82, v82, v92
    v_mfma_f32_16x16x32_bf16 v[32:35], v[160:163], v[180:183], v[32:35]
    ds_read_b64 v[172:173], v2 offset:40960
    v_add_f32_e64 v83, v83, v93
    v_mfma_f32_16x16x32_bf16 v[32:35], v[168:171], v[220:223], v[32:35]
    ds_read_b64 v[174:175], v2 offset:40968
    v_add_f32_e64 v84, v84, v90
    v_mfma_f32_16x16x32_bf16 v[36:39], v[160:163], v[164:167], v[36:39]
    ds_read_b128 v[144:147], v3 offset:38400
    v_add_f32_e64 v85, v85, v91
    v_mfma_f32_16x16x32_bf16 v[36:39], v[208:211], v[220:223], v[36:39]
    v_add_f32 v86, v86, v94
    v_add_f32 v87, v87, v95
    v_mfma_f32_16x16x32_bf16 v[40:43], v[160:163], v[212:215], v[40:43]
    s_waitcnt lgkmcnt(9)
    v_add_f32 v80, v80, v96
    v_add_f32_e64 v81, v81, v97
    v_mfma_f32_16x16x32_bf16 v[40:43], v[128:131], v[220:223], v[40:43]
    v_add_f32 v82, v82, v100
    v_add_f32 v83, v83, v101
    v_mfma_f32_16x16x32_bf16 v[44:47], v[160:163], v[140:143], 0
    v_add_f32 v84, v84, v98
    v_add_f32 v85, v85, v99
    v_mfma_f32_16x16x32_bf16 v[44:47], v[216:219], v[220:223], v[44:47]
    v_add_f32_e64 v86, v86, v102
    v_mfma_f32_16x16x32_bf16 v[36:39], v[200:203], v[180:183], v[36:39]
    ds_read_b64 v[192:193], v2 offset:40448
    v_add_f32_e64 v87, v87, v103
    v_mfma_f32_16x16x32_bf16 v[36:39], v[168:171], v[152:155], v[36:39]
    ds_read_b64 v[194:195], v2 offset:40456
    s_waitcnt lgkmcnt(7)
    v_add_f32 v80, v80, v104
    v_mfma_f32_16x16x32_bf16 v[40:43], v[200:203], v[164:167], v[40:43]
    ds_read_b128 v[120:123], v3 offset:38912
    v_add_f32_e64 v81, v81, v105
    v_mfma_f32_16x16x32_bf16 v[40:43], v[208:211], v[152:155], v[40:43]
    v_add_f32 v82, v82, v108
    v_add_f32 v83, v83, v109
    v_mfma_f32_16x16x32_bf16 v[44:47], v[200:203], v[212:215], v[44:47]
    v_add_f32 v84, v84, v106
    v_add_f32 v85, v85, v107
    v_mfma_f32_16x16x32_bf16 v[44:47], v[128:131], v[152:155], v[44:47]
    v_add_f32_e64 v86, v86, v110
    v_mfma_f32_16x16x32_bf16 v[40:43], v[184:187], v[180:183], v[40:43]
    ds_read_b64 v[124:125], v2 offset:39936
    v_add_f32_e64 v87, v87, v111
    v_mfma_f32_16x16x32_bf16 v[40:43], v[168:171], v[188:191], v[40:43]
    ds_read_b64 v[126:127], v2 offset:39944
    s_waitcnt lgkmcnt(8)
    v_add_f32 v80, v80, v112
    v_mfma_f32_16x16x32_bf16 v[44:47], v[184:187], v[164:167], v[44:47]
    ds_read_b128 v[204:207], v3 offset:39424
    v_add_f32_e64 v81, v81, v113
    v_mfma_f32_16x16x32_bf16 v[44:47], v[208:211], v[188:191], v[44:47]
    v_add_f32_e64 v82, v82, v116
    v_mfma_f32_16x16x32_bf16 v[44:47], v[156:159], v[180:183], v[44:47]
    ds_read_b64 v[224:225], v2 offset:39424
    v_add_f32_e64 v83, v83, v117
    v_mfma_f32_16x16x32_bf16 v[44:47], v[168:171], v[196:199], v[44:47]
    ds_read_b64 v[226:227], v2 offset:39432
    v_mfma_f32_16x16x32_bf16 v[16:19], v[148:151], v[136:139], v[16:19]
    ds_read_b128 v[176:179], v3 offset:39936
    s_waitcnt lgkmcnt(9)
    v_mfma_f32_16x16x32_bf16 v[20:23], v[172:175], v[136:139], v[20:23]
    ds_read_b64 v[132:133], v2 offset:38912
    v_add_f32 v84, v84, v114
    v_mfma_f32_16x16x32_bf16 v[20:23], v[148:151], v[144:147], v[20:23]
    ds_read_b64 v[134:135], v2 offset:38920
    v_add_f32_e64 v85, v85, v115
    v_mfma_f32_16x16x32_bf16 v[24:27], v[172:175], v[144:147], v[24:27]
    ds_read_b128 v[216:219], v3 offset:40448
    s_waitcnt lgkmcnt(9)
    v_mfma_f32_16x16x32_bf16 v[24:27], v[192:195], v[136:139], v[24:27]
    ds_read_b64 v[140:141], v2 offset:38400
    v_add_f32 v86, v86, v118
    v_mfma_f32_16x16x32_bf16 v[24:27], v[148:151], v[120:123], v[24:27]
    ds_read_b64 v[142:143], v2 offset:38408
    v_add_f32_e64 v87, v87, v119
    v_mfma_f32_16x16x32_bf16 v[28:31], v[192:195], v[144:147], v[28:31]
    ds_read_b128 v[160:163], v3 offset:40960
    v_cvt_pk_bf16_f32 v88, v80, v81
    v_mfma_f32_16x16x32_bf16 v[28:31], v[172:175], v[120:123], v[28:31]
    ds_read_b64 v[220:221], v2 offset:37888
    v_cvt_pk_bf16_f32 v89, v82, v83
    v_mfma_f32_16x16x32_bf16 v[32:35], v[192:195], v[120:123], v[32:35]
    ds_read_b64 v[222:223], v2 offset:37896
    s_waitcnt lgkmcnt(11)
    v_mfma_f32_16x16x32_bf16 v[28:31], v[124:127], v[136:139], v[28:31]
    ds_read_b128 v[128:131], v3 offset:41472
    v_cvt_pk_bf16_f32 v90, v84, v85
    v_mfma_f32_16x16x32_bf16 v[28:31], v[148:151], v[204:207], v[28:31]
    v_cvt_pk_bf16_f32 v91, v86, v87
    v_min_u32 v88, -2, v88
    v_mfma_f32_16x16x32_bf16 v[32:35], v[124:127], v[144:147], v[32:35]
    buffer_store_dwordx4 v[88:91], v1, s[36:39], s11 offen sc1
    buffer_load_dword v255, v254, s[36:39], s71 offen sc1
    v_mfma_f32_16x16x32_bf16 v[32:35], v[172:175], v[204:207], v[32:35]
    v_accvgpr_read_b32 v8, a240
    s_nop 0
    v_mfma_f32_16x16x32_bf16 v[36:39], v[124:127], v[120:123], v[36:39]
    s_add_u32 m0, s19, 0
    s_add_u32 s75, s18, 0
    v_mfma_f32_16x16x32_bf16 v[36:39], v[192:195], v[204:207], v[36:39]
    buffer_load_dwordx4 v8, s[36:39], s75 offen sc1 lds
    s_add_u32 m0, s19, 4096
    v_mfma_f32_16x16x32_bf16 v[40:43], v[124:127], v[204:207], v[40:43]
    s_add_u32 s75, s18, 655360
    s_waitcnt lgkmcnt(9)
    v_mfma_f32_16x16x32_bf16 v[32:35], v[224:227], v[136:139], v[32:35]
    buffer_load_dwordx4 v8, s[36:39], s75 offen sc1 lds
    s_add_u32 m0, s19, 8192
    v_mfma_f32_16x16x32_bf16 v[32:35], v[148:151], v[176:179], v[32:35]
    s_add_u32 s75, s18, 1310720
    buffer_load_dwordx4 v8, s[36:39], s75 offen sc1 lds
    v_mfma_f32_16x16x32_bf16 v[36:39], v[224:227], v[144:147], v[36:39]
    s_add_u32 m0, s19, 12288
    s_add_u32 s75, s18, 1966080
    v_mfma_f32_16x16x32_bf16 v[36:39], v[172:175], v[176:179], v[36:39]
    buffer_load_dwordx4 v8, s[36:39], s75 offen sc1 lds
    v_mfma_f32_16x16x32_bf16 v[40:43], v[224:227], v[120:123], v[40:43]
    v_mfma_f32_16x16x32_bf16 v[40:43], v[192:195], v[176:179], v[40:43]
    v_mfma_f32_16x16x32_bf16 v[44:47], v[224:227], v[204:207], v[44:47]
    v_mfma_f32_16x16x32_bf16 v[44:47], v[124:127], v[176:179], v[44:47]
    s_waitcnt lgkmcnt(6)
    v_mfma_f32_16x16x32_bf16 v[36:39], v[132:135], v[136:139], v[36:39]
    v_mfma_f32_16x16x32_bf16 v[36:39], v[148:151], v[216:219], v[36:39]
    v_mfma_f32_16x16x32_bf16 v[40:43], v[132:135], v[144:147], v[40:43]
    v_mfma_f32_16x16x32_bf16 v[40:43], v[172:175], v[216:219], v[40:43]
    v_mfma_f32_16x16x32_bf16 v[44:47], v[132:135], v[120:123], v[44:47]
    v_mfma_f32_16x16x32_bf16 v[44:47], v[192:195], v[216:219], v[44:47]
    s_waitcnt lgkmcnt(3)
    v_mfma_f32_16x16x32_bf16 v[40:43], v[140:143], v[136:139], v[40:43]
    v_mfma_f32_16x16x32_bf16 v[40:43], v[148:151], v[160:163], v[40:43]
    v_mfma_f32_16x16x32_bf16 v[44:47], v[140:143], v[144:147], v[44:47]
    v_mfma_f32_16x16x32_bf16 v[44:47], v[172:175], v[160:163], v[44:47]
    s_waitcnt lgkmcnt(0)
    v_mfma_f32_16x16x32_bf16 v[44:47], v[220:223], v[136:139], v[44:47]
    v_mfma_f32_16x16x32_bf16 v[44:47], v[148:151], v[128:131], v[44:47]
    s_mov_b32 s70, 0
    s_waitcnt vmcnt(4)
    v_cmp_ne_u32 vcc, s56, v255
    s_cbranch_vccz POLLD0
POLL0:
    buffer_load_dword v255, v254, s[36:39], s71 offen sc1
    s_add_u32 s70, s70, 1
    s_cmp_gt_u32 s70, 200000
    s_waitcnt vmcnt(0)
    s_cbranch_scc1 POLLD0
    v_cmp_ne_u32 vcc, s56, v255
    s_cbranch_vccnz POLL0
POLLD0:
    buffer_load_dwordx4 a[0:3], v241, s[36:39], s13 offen offset:0 sc1
    buffer_load_dwordx4 a[4:7], v241, s[36:39], s13 offen offset:1024 sc1
    buffer_load_dwordx4 a[8:11], v241, s[36:39], s13 offen offset:2048 sc1
    s_add_u32 s13, s13, 196608
    buffer_load_dwordx4 a[12:15], v241, s[36:39], s13 offen offset:0 sc1
    buffer_load_dwordx4 a[16:19], v241, s[36:39], s13 offen offset:1024 sc1
    buffer_load_dwordx4 a[20:23], v241, s[36:39], s13 offen offset:2048 sc1
    s_add_u32 s13, s13, 196608
    ds_write_b128 v7, v[16:19] offset:0
    ds_write_b128 v7, v[20:23] offset:512
    ds_write_b128 v7, v[24:27] offset:1024
    ds_write_b128 v7, v[28:31] offset:1536
    ds_write_b128 v7, v[32:35] offset:2048
    ds_write_b128 v7, v[36:39] offset:2560
    ds_write_b128 v7, v[40:43] offset:3072
    ds_write_b128 v7, v[44:47] offset:3584
    v_accvgpr_read_b32 v128, a240
    v_accvgpr_read_b32 v129, a241
    v_accvgpr_read_b32 v132, a244
    v_accvgpr_read_b32 v136, a245
    v_accvgpr_read_b32 v137, a246
    v_xor_b32 v133, 32, v132
    v_xor_b32 v134, 64, v132
    v_xor_b32 v135, 96, v132
    v_mov_b32 v208, s65
    v_mov_b32 v209, s65
    v_mov_b32 v210, s65
    v_mov_b32 v211, s65
    s_waitcnt lgkmcnt(0)
    s_barrier
    ds_read_b128 v[80:83], v249 offset:16384
    ds_read_b128 v[84:87], v249 offset:16400
    ds_read_b128 v[88:91], v14 offset:0
    ds_read_b128 v[92:95], v15 offset:4096
    ds_read_b128 v[96:99], v14 offset:8192
    ds_read_b128 v[100:103], v15 offset:12288
    ds_read_b128 v[104:107], v14 offset:16384
    ds_read_b128 v[108:111], v15 offset:20480
    ds_read_b128 v[112:115], v14 offset:24576
    ds_read_b128 v[116:119], v15 offset:28672
    s_waitcnt lgkmcnt(7)
    v_pk_add_f32 v[80:81], v[80:81], v[88:89]
    s_waitcnt lgkmcnt(6)
    v_pk_add_f32 v[82:83], v[82:83], v[92:93]
    v_pk_add_f32 v[84:85], v[84:85], v[90:91]
    v_pk_add_f32 v[86:87], v[86:87], v[94:95]
    s_waitcnt lgkmcnt(5)
    v_pk_add_f32 v[80:81], v[80:81], v[96:97]
    s_waitcnt lgkmcnt(4)
    v_pk_add_f32 v[82:83], v[82:83], v[100:101]
    v_pk_add_f32 v[84:85], v[84:85], v[98:99]
    v_pk_add_f32 v[86:87], v[86:87], v[102:103]
    s_waitcnt lgkmcnt(3)
    v_pk_add_f32 v[80:81], v[80:81], v[104:105]
    s_waitcnt lgkmcnt(2)
    v_pk_add_f32 v[82:83], v[82:83], v[108:109]
    v_pk_add_f32 v[84:85], v[84:85], v[106:107]
    v_pk_add_f32 v[86:87], v[86:87], v[110:111]
    s_waitcnt lgkmcnt(1)
    v_pk_add_f32 v[80:81], v[80:81], v[112:113]
    s_waitcnt lgkmcnt(0)
    v_pk_add_f32 v[82:83], v[82:83], v[116:117]
    v_pk_add_f32 v[84:85], v[84:85], v[114:115]
    v_pk_add_f32 v[86:87], v[86:87], v[118:119]
    v_cvt_pk_bf16_f32 v88, v80, v81
    v_cvt_pk_bf16_f32 v89, v82, v83
    v_cvt_pk_bf16_f32 v90, v84, v85
    v_cvt_pk_bf16_f32 v91, v86, v87
    v_min_u32_e64 v88, -2, v88
    buffer_store_dwordx4 v[88:91], v1, s[36:39], s12 offen sc1
    v_add_u32_e64 v131, s19, v241
    v_add_u32 v252, 0x10000, v131
    v_add_u32 v253, 0x20000, v131
    buffer_load_dwordx4 a[24:27], v241, s[36:39], s13 offen offset:0 sc1
    buffer_load_dwordx4 a[28:31], v241, s[36:39], s13 offen offset:1024 sc1
    buffer_load_dwordx4 a[32:35], v241, s[36:39], s13 offen offset:2048 sc1
    s_add_u32 s13, s13, 196608
    s_add_u32 m0, s19, 16384
    s_add_u32 s75, s18, 128
    buffer_load_dwordx4 v128, s[36:39], s75 offen sc1 lds
    s_add_u32 m0, s19, 20480
    s_add_u32 s75, s18, 655488
    buffer_load_dwordx4 v128, s[36:39], s75 offen sc1 lds
    s_add_u32 m0, s19, 24576
    s_add_u32 s75, s18, 1310848
    buffer_load_dwordx4 v128, s[36:39], s75 offen sc1 lds
    s_add_u32 m0, s19, 28672
    s_add_u32 s75, s18, 1966208
    buffer_load_dwordx4 v128, s[36:39], s75 offen sc1 lds
    s_waitcnt vmcnt(14)
    ds_read_b32 v170, v131 offset:0
    ds_read_b32 v171, v131 offset:4096
    ds_read_b32 v254, v131 offset:8192
    ds_read_b32 v251, v131 offset:12288
    s_nop 0
    s_nop 0
    s_nop 0
    s_nop 0
    s_waitcnt lgkmcnt(1)
    v_max3_u32 v170, v170, v171, v254
    s_waitcnt lgkmcnt(0)
    v_max_u32 v170, v170, v251
    v_cmp_eq_u32 vcc, -1, v170
    s_cbranch_vccnz RTY0
CNT0:
    s_barrier
    s_nop 0
    ds_read_b64_tr_b16 v[96:97], v132 offset:0
    ds_read_b64_tr_b16 v[98:99], v132 offset:512
    ds_read_b64_tr_b16 v[100:101], v133 offset:0
    ds_read_b64_tr_b16 v[102:103], v133 offset:512
    ds_read_b64_tr_b16 v[104:105], v134 offset:0
    ds_read_b64_tr_b16 v[106:107], v134 offset:512
    ds_read_b64_tr_b16 v[108:109], v135 offset:0
    ds_read_b64_tr_b16 v[110:111], v135 offset:512
    s_waitcnt vmcnt(11) lgkmcnt(0)
    s_nop 0
    v_mfma_f32_16x16x32_bf16 v[200:203], v[208:211], v[96:99], 0
    ds_read_b64_tr_b16 v[112:113], v132 offset:4096
    ds_read_b64_tr_b16 v[48:49], v237 offset:0
    ds_read_b64_tr_b16 v[50:51], v237 offset:2560
    v_mfma_f32_16x16x32_bf16 v[204:207], v[96:99], v[96:99], 0
    ds_read_b64_tr_b16 v[114:115], v132 offset:4608
    buffer_load_dwordx4 a[36:39], v241, s[36:39], s13 offen offset:0 sc1
    ds_read_b64_tr_b16 v[52:53], v237 offset:8
    v_mfma_f32_16x16x32_bf16 v[0:3], a[0:3], v[96:99], 0
    ds_read_b64_tr_b16 v[116:117], v133 offset:4096
    ds_read_b64_tr_b16 v[54:55], v237 offset:2568
    ds_read_b64_tr_b16 v[56:57], v237 offset:64
    v_mfma_f32_16x16x32_bf16 v[4:7], a[4:7], v[96:99], 0
    ds_read_b64_tr_b16 v[118:119], v133 offset:4608
    ds_read_b64_tr_b16 v[58:59], v237 offset:2624
    ds_read_b64_tr_b16 v[60:61], v237 offset:72
    v_mfma_f32_16x16x32_bf16 v[8:11], a[8:11], v[96:99], 0
    ds_read_b64_tr_b16 v[120:121], v134 offset:4096
    ds_read_b64_tr_b16 v[62:63], v237 offset:2632
    ds_read_b64_tr_b16 v[64:65], v238 offset:128
    v_mfma_f32_16x16x32_bf16 v[12:15], a[0:3], v[100:103], 0
    ds_read_b64_tr_b16 v[122:123], v134 offset:4608
    buffer_load_dwordx4 a[40:43], v241, s[36:39], s13 offen offset:1024 sc1
    ds_read_b64_tr_b16 v[66:67], v238 offset:2688
    v_mfma_f32_16x16x32_bf16 v[16:19], a[4:7], v[100:103], 0
    ds_read_b64_tr_b16 v[124:125], v135 offset:4096
    s_nop 0
    s_nop 0
    v_mfma_f32_16x16x32_bf16 v[20:23], a[8:11], v[100:103], 0
    ds_read_b64_tr_b16 v[126:127], v135 offset:4608
    s_nop 0
    s_nop 0
    v_mfma_f32_16x16x32_bf16 v[24:27], a[0:3], v[104:107], 0
    s_waitcnt lgkmcnt(15)
    buffer_store_dwordx4 v[48:51], v241, s[36:39], s29 offen offset:0 sc1
    s_waitcnt lgkmcnt(11)
    buffer_store_dwordx4 v[52:55], v241, s[36:39], s29 offen offset:1024 sc1
    s_waitcnt lgkmcnt(8)
    buffer_store_dwordx4 v[56:59], v241, s[36:39], s29 offen offset:2048 sc1
    v_mfma_f32_16x16x32_bf16 v[28:31], a[4:7], v[104:107], 0
    buffer_load_dwordx4 a[44:47], v241, s[36:39], s13 offen offset:2048 sc1
    s_add_u32 s13, s13, 196608
    s_waitcnt lgkmcnt(5)
    buffer_store_dwordx4 v[60:63], v241, s[36:39], s29 offen offset:3072 sc1
    v_mfma_f32_16x16x32_bf16 v[32:35], a[8:11], v[104:107], 0
    s_add_u32 s29, s29, 4096
    s_waitcnt lgkmcnt(2)
    s_nop 0
    buffer_store_dwordx4 v[64:67], v241, s[36:39], s29 offen offset:0 sc1
    buffer_load_dwordx4 v[188:191], v136, s[36:39], s14 offen offset:0 sc1
    v_mfma_f32_16x16x32_bf16 v[36:39], a[0:3], v[108:111], 0
    buffer_load_dwordx4 v[176:179], v137, s[36:39], s14 offen offset:0 sc1
    buffer_load_dwordx4 v[192:195], v136, s[36:39], s14 offen offset:64 sc1
    buffer_load_dwordx4 v[180:183], v137, s[36:39], s14 offen offset:64 sc1
    v_mfma_f32_16x16x32_bf16 v[40:43], a[4:7], v[108:111], 0
    buffer_load_dwordx4 v[196:199], v136, s[36:39], s14 offen offset:128 sc1
    buffer_load_dwordx4 v[184:187], v137, s[36:39], s14 offen offset:128 sc1
    v_lshrrev_b32_e64 v162, 4, v240
    v_mfma_f32_16x16x32_bf16 v[44:47], a[8:11], v[108:111], 0
    v_bfe_u32 v163, v240, 2, 2
    v_and_b32 v164, 3, v240
    s_waitcnt vmcnt(22) lgkmcnt(0)
    v_mfma_f32_16x16x32_bf16 v[200:203], v[208:211], v[112:115], v[200:203]
    ds_read_b64_tr_b16 v[96:97], v132 offset:8192
    s_lshr_b32 s72, s62, 3
    s_lshl_b32 s72, s72, 1
    v_mfma_f32_16x16x32_bf16 v[204:207], v[112:115], v[112:115], v[204:207]
    ds_read_b64_tr_b16 v[98:99], v132 offset:8704
    s_add_u32 m0, s19, 32768
    s_add_u32 s75, s18, 0
    v_mfma_f32_16x16x32_bf16 v[0:3], a[12:15], v[112:115], v[0:3]
    ds_read_b64_tr_b16 v[100:101], v133 offset:8192
    buffer_load_dwordx4 v129, s[36:39], s75 offen sc1 lds
    s_lshr_b32 s73, s3, 1
    v_mfma_f32_16x16x32_bf16 v[4:7], a[16:19], v[112:115], v[4:7]
    ds_read_b64_tr_b16 v[102:103], v133 offset:8704
    s_add_u32 s72, s72, s73
    s_and_b32 s73, s62, 7
    v_mfma_f32_16x16x32_bf16 v[8:11], a[20:23], v[112:115], v[8:11]
    ds_read_b64_tr_b16 v[104:105], v134 offset:8192
    s_lshl_b32 s73, s73, 4
    s_and_b32 s74, s3, 1
    v_mfma_f32_16x16x32_bf16 v[12:15], a[12:15], v[116:119], v[12:15]
    ds_read_b64_tr_b16 v[106:107], v134 offset:8704
    s_add_u32 m0, s19, 36864
    s_add_u32 s75, s18, 327680
    v_mfma_f32_16x16x32_bf16 v[16:19], a[16:19], v[116:119], v[16:19]
    ds_read_b64_tr_b16 v[108:109], v135 offset:8192
    buffer_load_dwordx4 v129, s[36:39], s75 offen sc1 lds
    s_lshl_b32 s74, s74, 5
    v_mfma_f32_16x16x32_bf16 v[20:23], a[20:23], v[116:119], v[20:23]
    ds_read_b64_tr_b16 v[110:111], v135 offset:8704
    v_lshl_add_u32 v165, v162, 3, v163
    v_add3_u32 v165, v165, s74, 0
    v_mfma_f32_16x16x32_bf16 v[24:27], a[12:15], v[120:123], v[24:27]
    v_mul_u32_u24 v166, 205, v165
    v_lshrrev_b32 v166, 10, v166
    v_mul_u32_u24_e64 v167, 5, v166
    v_mfma_f32_16x16x32_bf16 v[28:31], a[16:19], v[120:123], v[28:31]
    s_add_u32 m0, s19, 40960
    s_add_u32 s75, s18, 655360
    buffer_load_dwordx4 v129, s[36:39], s75 offen sc1 lds
    v_mfma_f32_16x16x32_bf16 v[32:35], a[20:23], v[120:123], v[32:35]
    v_sub_u32 v167, v165, v167
    v_add_u32 v166, s73, v166
    v_cmp_lt_u32 s[76:77], 2, v167
    v_mfma_f32_16x16x32_bf16 v[36:39], a[12:15], v[124:127], v[36:39]
    v_cmp_eq_u32 s[78:79], 2, v167
    v_subrev_u32_e64 v169, 3, v167
    v_cndmask_b32 v169, v167, v169, s[76:77]
    v_mfma_f32_16x16x32_bf16 v[40:43], a[16:19], v[124:127], v[40:43]
    v_cndmask_b32 v168, 0, 1, s[76:77]
    v_lshl_add_u32 v168, v166, 1, v168
    v_lshl_add_u32 v168, v169, 8, v168
    v_mfma_f32_16x16x32_bf16 v[44:47], a[20:23], v[124:127], v[44:47]
    v_add_u32 v168, 128, v168
    v_cndmask_b32 v168, v168, v166, s[78:79]
    s_waitcnt vmcnt(21) lgkmcnt(0)
    s_nop 0
    v_mfma_f32_16x16x32_bf16 v[200:203], v[208:211], v[96:99], v[200:203]
    ds_read_b64_tr_b16 v[112:113], v132 offset:12288
    v_bfe_u32 v166, v168, 1, 1
    v_bfe_u32 v167, v168, 3, 1
    v_mfma_f32_16x16x32_bf16 v[204:207], v[96:99], v[96:99], v[204:207]
    ds_read_b64_tr_b16 v[114:115], v132 offset:12800
    s_add_u32 m0, s19, 45056
    s_add_u32 s75, s18, 983040
    v_mfma_f32_16x16x32_bf16 v[0:3], a[24:27], v[96:99], v[0:3]
    ds_read_b64_tr_b16 v[116:117], v133 offset:12288
    buffer_load_dwordx4 v129, s[36:39], s75 offen sc1 lds
    v_lshl_add_u32 v166, v167, 1, v166
    v_mfma_f32_16x16x32_bf16 v[4:7], a[28:31], v[96:99], v[4:7]
    ds_read_b64_tr_b16 v[118:119], v133 offset:12800
    s_waitcnt vmcnt(18)
    s_nop 0
    ds_read_b32 v170, v131 offset:16384
    ds_read_b32 v171, v131 offset:20480
    v_mfma_f32_16x16x32_bf16 v[8:11], a[32:35], v[96:99], v[8:11]
    ds_read_b64_tr_b16 v[120:121], v134 offset:12288
    ds_read_b32 v254, v131 offset:24576
    ds_read_b32 v251, v131 offset:28672
    v_mfma_f32_16x16x32_bf16 v[12:15], a[24:27], v[100:103], v[12:15]
    ds_read_b64_tr_b16 v[122:123], v134 offset:12800
    buffer_load_dwordx4 a[48:51], v241, s[36:39], s13 offen offset:0 sc1
    v_xor_b32_e64 v166, s72, v166
    v_mfma_f32_16x16x32_bf16 v[16:19], a[28:31], v[100:103], v[16:19]
    ds_read_b64_tr_b16 v[124:125], v135 offset:12288
    v_lshrrev_b32 v167, 5, v168
    v_lshlrev_b32 v168, 7, v168
    v_mfma_f32_16x16x32_bf16 v[20:23], a[32:35], v[100:103], v[20:23]
    ds_read_b64_tr_b16 v[126:127], v135 offset:12800
    v_lshl_add_u32 v168, v166, 5, v168
    s_waitcnt lgkmcnt(4)
    v_max3_u32 v170, v170, v171, v254
    v_mfma_f32_16x16x32_bf16 v[24:27], a[24:27], v[104:107], v[24:27]
    s_waitcnt lgkmcnt(3)
    v_max_u32_e64 v170, v170, v251
    v_lshl_add_u32 v168, v164, 3, v168
    v_cmp_gt_u32 s[76:77], 4, v167
    v_mfma_f32_16x16x32_bf16 v[28:31], a[28:31], v[104:107], v[28:31]
    buffer_load_dwordx4 a[52:55], v241, s[36:39], s13 offen offset:1024 sc1
    v_subrev_u32 v166, 8, v167
    v_max_i32 v166, 4, v166
    v_mfma_f32_16x16x32_bf16 v[32:35], a[32:35], v[104:107], v[32:35]
    v_cndmask_b32 v166, v166, 0, s[76:77]
    v_lshl_add_u32 v138, v166, 12, v168
    v_add_u32_e64 v166, 9, v167
    v_mfma_f32_16x16x32_bf16 v[36:39], a[24:27], v[108:111], v[36:39]
    v_min_u32_e64 v166, 20, v166
    v_cndmask_b32 v166, v166, 4, s[76:77]
    v_lshl_add_u32 v146, v166, 12, v168
    v_mfma_f32_16x16x32_bf16 v[40:43], a[28:31], v[108:111], v[40:43]
    v_lshl_add_u32 v165, v162, 3, v163
    v_add3_u32 v165, v165, s74, 4
    v_mul_u32_u24 v166, 205, v165
    v_mfma_f32_16x16x32_bf16 v[44:47], a[32:35], v[108:111], v[44:47]
    v_lshrrev_b32 v166, 10, v166
    v_mul_u32_u24 v167, 5, v166
    v_cmp_eq_u32 vcc, -1, v170
    s_cbranch_vccnz RTY1
CNT1:
    s_barrier
    s_waitcnt vmcnt(14) lgkmcnt(0)
    v_mfma_f32_16x16x32_bf16 v[200:203], v[208:211], v[112:115], v[200:203]
    ds_read_b64_tr_b16 v[96:97], v132 offset:16384
    v_sub_u32_e64 v167, v165, v167
    v_mfma_f32_16x16x32_bf16 v[204:207], v[112:115], v[112:115], v[204:207]
    ds_read_b64_tr_b16 v[98:99], v132 offset:16896
    buffer_load_dwordx4 a[56:59], v241, s[36:39], s13 offen offset:2048 sc1
    v_mfma_f32_16x16x32_bf16 v[0:3], a[36:39], v[112:115], v[0:3]
    ds_read_b64_tr_b16 v[100:101], v133 offset:16384
    s_add_u32 s13, s13, 196608
    v_mfma_f32_16x16x32_bf16 v[4:7], a[40:43], v[112:115], v[4:7]
    ds_read_b64_tr_b16 v[102:103], v133 offset:16896
    v_add_u32_e64 v166, s73, v166
    v_mfma_f32_16x16x32_bf16 v[8:11], a[44:47], v[112:115], v[8:11]
    ds_read_b64_tr_b16 v[104:105], v134 offset:16384
    v_cmp_lt_u32 s[76:77], 2, v167
    v_mfma_f32_16x16x32_bf16 v[12:15], a[36:39], v[116:119], v[12:15]
    ds_read_b64_tr_b16 v[106:107], v134 offset:16896
    buffer_load_dwordx4 a[60:63], v241, s[36:39], s13 offen offset:0 sc1
    v_mfma_f32_16x16x32_bf16 v[16:19], a[40:43], v[116:119], v[16:19]
    ds_read_b64_tr_b16 v[108:109], v135 offset:16384
    v_cmp_eq_u32 s[78:79], 2, v167
    v_mfma_f32_16x16x32_bf16 v[20:23], a[44:47], v[116:119], v[20:23]
    ds_read_b64_tr_b16 v[110:111], v135 offset:16896
    v_subrev_u32_e64 v169, 3, v167
    v_mfma_f32_16x16x32_bf16 v[24:27], a[36:39], v[120:123], v[24:27]
    v_cndmask_b32 v169, v167, v169, s[76:77]
    v_cndmask_b32 v168, 0, 1, s[76:77]
    v_mfma_f32_16x16x32_bf16 v[28:31], a[40:43], v[120:123], v[28:31]
    buffer_load_dwordx4 a[64:67], v241, s[36:39], s13 offen offset:1024 sc1
    v_lshl_add_u32 v168, v166, 1, v168
    v_mfma_f32_16x16x32_bf16 v[32:35], a[44:47], v[120:123], v[32:35]
    v_lshl_add_u32 v168, v169, 8, v168
    v_add_u32 v168, 128, v168
    v_mfma_f32_16x16x32_bf16 v[36:39], a[36:39], v[124:127], v[36:39]
    v_cndmask_b32 v168, v168, v166, s[78:79]
    v_bfe_u32 v166, v168, 1, 1
    v_mfma_f32_16x16x32_bf16 v[40:43], a[40:43], v[124:127], v[40:43]
    v_bfe_u32 v167, v168, 3, 1
    v_lshl_add_u32 v166, v167, 1, v166
    v_mfma_f32_16x16x32_bf16 v[44:47], a[44:47], v[124:127], v[44:47]
    v_xor_b32 v166, s72, v166
    s_waitcnt lgkmcnt(0)
    v_mfma_f32_16x16x32_bf16 a[248:251], v[208:211], v[96:99], 0
    ds_read_b64_tr_b16 v[112:113], v132 offset:20480
    v_lshrrev_b32_e64 v167, 5, v168
    v_mfma_f32_16x16x32_bf16 a[252:255], v[96:99], v[96:99], 0
    ds_read_b64_tr_b16 v[114:115], v132 offset:20992
    buffer_load_dwordx4 a[68:71], v241, s[36:39], s13 offen offset:2048 sc1
    v_mfma_f32_16x16x32_bf16 v[48:51], a[0:3], v[96:99], 0
    ds_read_b64_tr_b16 v[116:117], v133 offset:20480
    s_add_u32 s13, s13, 196608
    v_mfma_f32_16x16x32_bf16 v[52:55], a[4:7], v[96:99], 0
    ds_read_b64_tr_b16 v[118:119], v133 offset:20992
    v_lshlrev_b32_e64 v168, 7, v168
    v_mfma_f32_16x16x32_bf16 v[56:59], a[8:11], v[96:99], 0
    ds_read_b64_tr_b16 v[120:121], v134 offset:20480
    buffer_load_dwordx4 a[72:75], v241, s[36:39], s13 offen offset:0 sc1
    v_mfma_f32_16x16x32_bf16 v[60:63], a[0:3], v[100:103], 0
    ds_read_b64_tr_b16 v[122:123], v134 offset:20992
    v_lshl_add_u32 v168, v166, 5, v168
    v_mfma_f32_16x16x32_bf16 v[64:67], a[4:7], v[100:103], 0
    ds_read_b64_tr_b16 v[124:125], v135 offset:20480
    v_lshl_add_u32 v168, v164, 3, v168
    v_mfma_f32_16x16x32_bf16 v[68:71], a[8:11], v[100:103], 0
    ds_read_b64_tr_b16 v[126:127], v135 offset:20992
    buffer_load_dwordx4 a[76:79], v241, s[36:39], s13 offen offset:1024 sc1
    v_mfma_f32_16x16x32_bf16 v[72:75], a[0:3], v[104:107], 0
    v_cmp_gt_u32 s[76:77], 4, v167
    v_subrev_u32_e64 v166, 8, v167
    v_mfma_f32_16x16x32_bf16 v[76:79], a[4:7], v[104:107], 0
    v_max_i32_e64 v166, 4, v166
    v_cndmask_b32 v166, v166, 0, s[76:77]
    v_mfma_f32_16x16x32_bf16 v[80:83], a[8:11], v[104:107], 0
    buffer_load_dwordx4 a[80:83], v241, s[36:39], s13 offen offset:2048 sc1
    s_add_u32 s13, s13, 196608
    v_mfma_f32_16x16x32_bf16 v[84:87], a[0:3], v[108:111], 0
    v_lshl_add_u32 v139, v166, 12, v168
    v_add_u32_e64 v166, 9, v167
    v_mfma_f32_16x16x32_bf16 v[88:91], a[4:7], v[108:111], 0
    v_min_u32_e64 v166, 20, v166
    v_cndmask_b32 v166, v166, 4, s[76:77]
    v_mfma_f32_16x16x32_bf16 v[92:95], a[8:11], v[108:111], 0
    v_lshl_add_u32 v147, v166, 12, v168
    s_waitcnt lgkmcnt(0)
    s_nop 0
    v_mfma_f32_16x16x32_bf16 a[248:251], v[208:211], v[112:115], a[248:251]
    ds_read_b64_tr_b16 v[96:97], v132 offset:24576
    v_lshl_add_u32 v165, v162, 2, v163
    v_mfma_f32_16x16x32_bf16 a[252:255], v[112:115], v[112:115], a[252:255]
    ds_read_b64_tr_b16 v[98:99], v132 offset:25088
    s_add_u32 m0, s19, 49152
    v_mfma_f32_16x16x32_bf16 v[48:51], a[12:15], v[112:115], v[48:51]
    ds_read_b64_tr_b16 v[100:101], v133 offset:24576
    s_add_u32 s75, s18, 1310720
    v_mfma_f32_16x16x32_bf16 v[52:55], a[16:19], v[112:115], v[52:55]
    ds_read_b64_tr_b16 v[102:103], v133 offset:25088
    buffer_load_dwordx4 v129, s[36:39], s75 offen sc1 lds
    v_mfma_f32_16x16x32_bf16 v[56:59], a[20:23], v[112:115], v[56:59]
    ds_read_b64_tr_b16 v[104:105], v134 offset:24576
    v_add_u32_e64 v165, 64, v165
    v_mfma_f32_16x16x32_bf16 v[60:63], a[12:15], v[116:119], v[60:63]
    ds_read_b64_tr_b16 v[106:107], v134 offset:25088
    s_add_u32 m0, s19, 53248
    v_mfma_f32_16x16x32_bf16 v[64:67], a[16:19], v[116:119], v[64:67]
    ds_read_b64_tr_b16 v[108:109], v135 offset:24576
    s_add_u32 s75, s18, 1638400
    v_mfma_f32_16x16x32_bf16 v[68:71], a[20:23], v[116:119], v[68:71]
    ds_read_b64_tr_b16 v[110:111], v135 offset:25088
    buffer_load_dwordx4 v129, s[36:39], s75 offen sc1 lds
    v_mfma_f32_16x16x32_bf16 v[72:75], a[12:15], v[120:123], v[72:75]
    v_mul_u32_u24 v166, 205, v165
    v_lshrrev_b32_e64 v166, 10, v166
    v_mfma_f32_16x16x32_bf16 v[76:79], a[16:19], v[120:123], v[76:79]
    s_add_u32 m0, s19, 57344
    s_add_u32 s75, s18, 1966080
    v_mfma_f32_16x16x32_bf16 v[80:83], a[20:23], v[120:123], v[80:83]
    buffer_load_dwordx4 v129, s[36:39], s75 offen sc1 lds
    v_mul_u32_u24_e64 v167, 5, v166
    v_mfma_f32_16x16x32_bf16 v[84:87], a[12:15], v[124:127], v[84:87]
    v_sub_u32 v167, v165, v167
    v_add_u32 v166, s73, v166
    v_mfma_f32_16x16x32_bf16 v[88:91], a[16:19], v[124:127], v[88:91]
    v_cmp_lt_u32 s[76:77], 2, v167
    v_cmp_eq_u32 s[78:79], 2, v167
    v_mfma_f32_16x16x32_bf16 v[92:95], a[20:23], v[124:127], v[92:95]
    v_subrev_u32 v169, 3, v167
    s_waitcnt lgkmcnt(0)
    v_mfma_f32_16x16x32_bf16 a[248:251], v[208:211], v[96:99], a[248:251]
    ds_read_b64_tr_b16 v[112:113], v132 offset:28672
    v_cndmask_b32 v169, v167, v169, s[76:77]
    v_mfma_f32_16x16x32_bf16 a[252:255], v[96:99], v[96:99], a[252:255]
    ds_read_b64_tr_b16 v[114:115], v132 offset:29184
    s_add_u32 m0, s19, 61440
    v_mfma_f32_16x16x32_bf16 v[48:51], a[24:27], v[96:99], v[48:51]
    ds_read_b64_tr_b16 v[116:117], v133 offset:28672
    s_add_u32 s75, s18, 2293760
    v_mfma_f32_16x16x32_bf16 v[52:55], a[28:31], v[96:99], v[52:55]
    ds_read_b64_tr_b16 v[118:119], v133 offset:29184
    buffer_load_dwordx4 v129, s[36:39], s75 offen sc1 lds
    v_mfma_f32_16x16x32_bf16 v[56:59], a[32:35], v[96:99], v[56:59]
    ds_read_b64_tr_b16 v[120:121], v134 offset:28672
    v_cndmask_b32 v168, 0, 1, s[76:77]
    v_mfma_f32_16x16x32_bf16 v[60:63], a[24:27], v[100:103], v[60:63]
    ds_read_b64_tr_b16 v[122:123], v134 offset:29184
    buffer_load_dwordx4 a[84:87], v241, s[36:39], s13 offen offset:0 sc1
    v_mfma_f32_16x16x32_bf16 v[64:67], a[28:31], v[100:103], v[64:67]
    ds_read_b64_tr_b16 v[124:125], v135 offset:28672
    v_lshl_add_u32 v168, v166, 1, v168
    v_mfma_f32_16x16x32_bf16 v[68:71], a[32:35], v[100:103], v[68:71]
    ds_read_b64_tr_b16 v[126:127], v135 offset:29184
    s_waitcnt vmcnt(14)
    s_nop 0
    ds_read_b32 v170, v131 offset:32768
    v_mfma_f32_16x16x32_bf16 v[72:75], a[24:27], v[104:107], v[72:75]
    ds_read_b32 v171, v131 offset:36864
    ds_read_b32 v254, v131 offset:40960
    v_mfma_f32_16x16x32_bf16 v[76:79], a[28:31], v[104:107], v[76:79]
    buffer_load_dwordx4 a[88:91], v241, s[36:39], s13 offen offset:1024 sc1
    ds_read_b32 v251, v131 offset:45056
    v_mfma_f32_16x16x32_bf16 v[80:83], a[32:35], v[104:107], v[80:83]
    v_lshl_add_u32 v168, v169, 8, v168
    v_add_u32 v168, 128, v168
    v_mfma_f32_16x16x32_bf16 v[84:87], a[24:27], v[108:111], v[84:87]
    v_cndmask_b32 v168, v168, v166, s[78:79]
    v_bfe_u32 v166, v168, 1, 1
    v_mfma_f32_16x16x32_bf16 v[88:91], a[28:31], v[108:111], v[88:91]
    s_waitcnt lgkmcnt(1)
    v_max3_u32 v170, v170, v171, v254
    s_waitcnt lgkmcnt(0)
    v_max_u32_e64 v170, v170, v251
    v_mfma_f32_16x16x32_bf16 v[92:95], a[32:35], v[108:111], v[92:95]
    v_bfe_u32 v167, v168, 3, 1
    v_cmp_eq_u32 vcc, -1, v170
    s_cbranch_vccnz RTY2
CNT2:
    s_barrier
    s_nop 0
    v_mfma_f32_16x16x32_bf16 a[248:251], v[208:211], v[112:115], a[248:251]
    ds_read_b64_tr_b16 v[96:97], v132 offset:32768
    v_lshl_add_u32 v166, v167, 1, v166
    v_mfma_f32_16x16x32_bf16 a[252:255], v[112:115], v[112:115], a[252:255]
    ds_read_b64_tr_b16 v[98:99], v132 offset:33280
    buffer_load_dwordx4 a[92:95], v241, s[36:39], s13 offen offset:2048 sc1
    v_mfma_f32_16x16x32_bf16 v[48:51], a[36:39], v[112:115], v[48:51]
    ds_read_b64_tr_b16 v[100:101], v133 offset:32768
    s_add_u32 s13, s13, 196608
    v_mfma_f32_16x16x32_bf16 v[52:55], a[40:43], v[112:115], v[52:55]
    ds_read_b64_tr_b16 v[102:103], v133 offset:33280
    v_xor_b32_e64 v166, s72, v166
    v_mfma_f32_16x16x32_bf16 v[56:59], a[44:47], v[112:115], v[56:59]
    ds_read_b64_tr_b16 v[104:105], v134 offset:32768
    buffer_load_dwordx4 a[96:99], v241, s[36:39], s13 offen offset:0 sc1
    v_mfma_f32_16x16x32_bf16 v[60:63], a[36:39], v[116:119], v[60:63]
    ds_read_b64_tr_b16 v[106:107], v134 offset:33280
    v_lshrrev_b32_e64 v167, 5, v168
    v_mfma_f32_16x16x32_bf16 v[64:67], a[40:43], v[116:119], v[64:67]
    ds_read_b64_tr_b16 v[108:109], v135 offset:32768
    v_lshlrev_b32_e64 v168, 7, v168
    v_mfma_f32_16x16x32_bf16 v[68:71], a[44:47], v[116:119], v[68:71]
    ds_read_b64_tr_b16 v[110:111], v135 offset:33280
    buffer_load_dwordx4 a[100:103], v241, s[36:39], s13 offen offset:1024 sc1
    v_mfma_f32_16x16x32_bf16 v[72:75], a[36:39], v[120:123], v[72:75]
    v_lshl_add_u32 v168, v166, 5, v168
    v_lshl_add_u32 v168, v164, 3, v168
    v_mfma_f32_16x16x32_bf16 v[76:79], a[40:43], v[120:123], v[76:79]
    v_cmp_gt_u32 s[76:77], 4, v167
    v_subrev_u32_e64 v166, 8, v167
    v_mfma_f32_16x16x32_bf16 v[80:83], a[44:47], v[120:123], v[80:83]
    buffer_store_dword v243, v242, s[36:39], s30 offen sc1
    v_mfma_f32_16x16x32_bf16 v[84:87], a[36:39], v[124:127], v[84:87]
    v_max_i32_e64 v166, 4, v166
    v_cndmask_b32 v166, v166, 0, s[76:77]
    v_mfma_f32_16x16x32_bf16 v[88:91], a[40:43], v[124:127], v[88:91]
    v_lshl_add_u32 v140, v166, 12, v168
    v_add_u32_e64 v166, 9, v167
    v_mfma_f32_16x16x32_bf16 v[92:95], a[44:47], v[124:127], v[92:95]
    v_min_u32 v166, 20, v166
    s_waitcnt vmcnt(16) lgkmcnt(0)
    v_mfma_f32_16x16x32_bf16 v[200:203], v[208:211], v[96:99], v[200:203]
    ds_read_b64_tr_b16 v[112:113], v132 offset:36864
    v_cndmask_b32 v166, v166, 4, s[76:77]
    v_lshl_add_u32 v235, v166, 12, v168
    v_mfma_f32_16x16x32_bf16 v[204:207], v[96:99], v[96:99], v[204:207]
    ds_read_b64_tr_b16 v[114:115], v132 offset:37376
    buffer_load_dwordx4 a[104:107], v241, s[36:39], s13 offen offset:2048 sc1
    s_add_u32 s13, s13, 196608
    v_mfma_f32_16x16x32_bf16 v[0:3], a[48:51], v[96:99], v[0:3]
    ds_read_b64_tr_b16 v[116:117], v133 offset:36864
    v_and_b32 v165, 15, v240
    v_lshlrev_b32 v166, 2, v165
    v_mfma_f32_16x16x32_bf16 v[4:7], a[52:55], v[96:99], v[4:7]
    ds_read_b64_tr_b16 v[118:119], v133 offset:37376
    s_lshl_b32 s73, s3, 7
    s_add_u32 s73, s73, 57344
    v_mfma_f32_16x16x32_bf16 v[8:11], a[56:59], v[96:99], v[8:11]
    ds_read_b64_tr_b16 v[120:121], v134 offset:36864
    v_add_u32 v142, s73, v166
    s_lshl_b32 s73, s72, 7
    v_mfma_f32_16x16x32_bf16 v[12:15], a[48:51], v[100:103], v[12:15]
    ds_read_b64_tr_b16 v[122:123], v134 offset:37376
    buffer_load_dwordx4 a[108:111], v241, s[36:39], s13 offen offset:0 sc1
    s_add_u32 s73, s73, 57344
    v_mfma_f32_16x16x32_bf16 v[16:19], a[52:55], v[100:103], v[16:19]
    ds_read_b64_tr_b16 v[124:125], v135 offset:36864
    v_add_u32 v145, s73, v166
    v_cmp_eq_u32 s[76:77], v162, v163
    v_mfma_f32_16x16x32_bf16 v[20:23], a[56:59], v[100:103], v[20:23]
    ds_read_b64_tr_b16 v[126:127], v135 offset:37376
    v_add_u32_e64 v167, 64, v142
    v_mov_b32 v168, 58368
    v_mfma_f32_16x16x32_bf16 v[24:27], a[48:51], v[104:107], v[24:27]
    v_cndmask_b32 v143, v168, v167, s[76:77]
    s_mov_b32 s66, 0xaaaaaaaa
    s_mov_b32 s67, 0xaaaaaaaa
    v_mfma_f32_16x16x32_bf16 v[28:31], a[52:55], v[104:107], v[28:31]
    buffer_load_dwordx4 a[112:115], v241, s[36:39], s13 offen offset:1024 sc1
    s_mov_b32 s68, 0xcccccccc
    s_mov_b32 s69, 0xcccccccc
    v_mfma_f32_16x16x32_bf16 v[32:35], a[56:59], v[104:107], v[32:35]
    v_lshlrev_b32 v141, 2, v240
    v_add_u32 v141, s19, v141
    s_mul_i32 s73, s3, 3
    v_mfma_f32_16x16x32_bf16 v[36:39], a[48:51], v[108:111], v[36:39]
    s_add_u32 s73, s73, 0
    s_lshr_b32 s74, s73, 2
    s_lshl_b32 s74, s74, 12
    v_mfma_f32_16x16x32_bf16 v[40:43], a[52:55], v[108:111], v[40:43]
    s_and_b32 s73, s73, 3
    s_lshl_b32 s73, s73, 8
    s_add_u32 s73, s73, s74
    v_mfma_f32_16x16x32_bf16 v[44:47], a[56:59], v[108:111], v[44:47]
    v_add_u32 v216, s73, v141
    v_xor_b32 v219, 1024, v216
    s_waitcnt vmcnt(16) lgkmcnt(0)
    s_nop 0
    v_mfma_f32_16x16x32_bf16 v[200:203], v[208:211], v[112:115], v[200:203]
    ds_read_b64_tr_b16 v[96:97], v132 offset:40960
    v_xor_b32 v222, 2048, v216
    v_xor_b32 v225, 3072, v216
    v_mfma_f32_16x16x32_bf16 v[204:207], v[112:115], v[112:115], v[204:207]
    ds_read_b64_tr_b16 v[98:99], v132 offset:41472
    buffer_load_dwordx4 a[116:119], v241, s[36:39], s13 offen offset:2048 sc1
    s_add_u32 s13, s13, 196608
    v_mfma_f32_16x16x32_bf16 v[0:3], a[60:63], v[112:115], v[0:3]
    ds_read_b64_tr_b16 v[100:101], v133 offset:40960
    s_mul_i32 s73, s3, 3
    s_add_u32 s73, s73, 1
    v_mfma_f32_16x16x32_bf16 v[4:7], a[64:67], v[112:115], v[4:7]
    ds_read_b64_tr_b16 v[102:103], v133 offset:41472
    s_lshr_b32 s74, s73, 2
    s_lshl_b32 s74, s74, 12
    v_mfma_f32_16x16x32_bf16 v[8:11], a[68:71], v[112:115], v[8:11]
    ds_read_b64_tr_b16 v[104:105], v134 offset:40960
    buffer_load_dwordx4 a[120:123], v241, s[36:39], s13 offen offset:0 sc1
    s_and_b32 s73, s73, 3
    v_mfma_f32_16x16x32_bf16 v[12:15], a[60:63], v[116:119], v[12:15]
    ds_read_b64_tr_b16 v[106:107], v134 offset:41472
    s_lshl_b32 s73, s73, 8
    s_add_u32 s73, s73, s74
    v_mfma_f32_16x16x32_bf16 v[16:19], a[64:67], v[116:119], v[16:19]
    ds_read_b64_tr_b16 v[108:109], v135 offset:40960
    v_add_u32 v217, s73, v141
    v_xor_b32 v220, 1024, v217
    v_mfma_f32_16x16x32_bf16 v[20:23], a[68:71], v[116:119], v[20:23]
    ds_read_b64_tr_b16 v[110:111], v135 offset:41472
    buffer_load_dwordx4 a[124:127], v241, s[36:39], s13 offen offset:1024 sc1
    v_xor_b32 v223, 2048, v217
    v_mfma_f32_16x16x32_bf16 v[24:27], a[60:63], v[120:123], v[24:27]
    v_xor_b32 v226, 3072, v217
    s_mul_i32 s73, s3, 3
    s_add_u32 s73, s73, 2
    v_mfma_f32_16x16x32_bf16 v[28:31], a[64:67], v[120:123], v[28:31]
    s_lshr_b32 s74, s73, 2
    s_lshl_b32 s74, s74, 12
    s_and_b32 s73, s73, 3
    v_mfma_f32_16x16x32_bf16 v[32:35], a[68:71], v[120:123], v[32:35]
    buffer_load_dwordx4 a[128:131], v241, s[36:39], s13 offen offset:2048 sc1
    s_add_u32 s13, s13, 196608
    s_lshl_b32 s73, s73, 8
    v_mfma_f32_16x16x32_bf16 v[36:39], a[60:63], v[124:127], v[36:39]
    s_add_u32 s73, s73, s74
    v_add_u32 v218, s73, v141
    v_xor_b32 v221, 1024, v218
    v_mfma_f32_16x16x32_bf16 v[40:43], a[64:67], v[124:127], v[40:43]
    v_xor_b32 v224, 2048, v218
    v_xor_b32 v227, 3072, v218
    v_add_f32_e64 v188, v188, v176
    v_mfma_f32_16x16x32_bf16 v[44:47], a[68:71], v[124:127], v[44:47]
    v_add_f32 v189, v189, v177
    v_add_f32 v190, v190, v178
    s_waitcnt vmcnt(17) lgkmcnt(0)
    v_mfma_f32_16x16x32_bf16 v[200:203], v[208:211], v[96:99], v[200:203]
    ds_read_b64_tr_b16 v[112:113], v132 offset:45056
    v_add_f32 v191, v191, v179
    v_add_f32_e64 v192, v192, v180
    v_mfma_f32_16x16x32_bf16 v[204:207], v[96:99], v[96:99], v[204:207]
    ds_read_b64_tr_b16 v[114:115], v132 offset:45568
    s_add_u32 m0, s19, 65536
    s_add_u32 s75, s18, 4096
    v_mfma_f32_16x16x32_bf16 v[0:3], a[72:75], v[96:99], v[0:3]
    ds_read_b64_tr_b16 v[116:117], v133 offset:45056
    buffer_load_dwordx4 v129, s[36:39], s75 offen sc1 lds
    v_add_f32_e64 v193, v193, v181
    v_mfma_f32_16x16x32_bf16 v[4:7], a[76:79], v[96:99], v[4:7]
    ds_read_b64_tr_b16 v[118:119], v133 offset:45568
    s_waitcnt vmcnt(14)
    s_nop 0
    ds_read_b32 v170, v131 offset:49152
    ds_read_b32 v171, v131 offset:53248
    v_mfma_f32_16x16x32_bf16 v[8:11], a[80:83], v[96:99], v[8:11]
    ds_read_b64_tr_b16 v[120:121], v134 offset:45056
    ds_read_b32 v254, v131 offset:57344
    ds_read_b32 v251, v131 offset:61440
    v_mfma_f32_16x16x32_bf16 v[12:15], a[72:75], v[100:103], v[12:15]
    ds_read_b64_tr_b16 v[122:123], v134 offset:45568
    s_add_u32 m0, s19, 69632
    s_add_u32 s75, s18, 128
    v_mfma_f32_16x16x32_bf16 v[16:19], a[76:79], v[100:103], v[16:19]
    ds_read_b64_tr_b16 v[124:125], v135 offset:45056
    buffer_load_dwordx4 v129, s[36:39], s75 offen sc1 lds
    v_add_f32_e64 v194, v194, v182
    v_mfma_f32_16x16x32_bf16 v[20:23], a[80:83], v[100:103], v[20:23]
    ds_read_b64_tr_b16 v[126:127], v135 offset:45568
    v_add_f32 v195, v195, v183
    v_add_f32 v196, v196, v184
    v_mfma_f32_16x16x32_bf16 v[24:27], a[72:75], v[104:107], v[24:27]
    v_add_f32 v197, v197, v185
    s_waitcnt lgkmcnt(4)
    v_max3_u32 v170, v170, v171, v254
    s_waitcnt lgkmcnt(3)
    v_max_u32 v170, v170, v251
    v_mfma_f32_16x16x32_bf16 v[28:31], a[76:79], v[104:107], v[28:31]
    s_add_u32 m0, s19, 73728
    s_add_u32 s75, s18, 331776
    buffer_load_dwordx4 v129, s[36:39], s75 offen sc1 lds
    v_mfma_f32_16x16x32_bf16 v[32:35], a[80:83], v[104:107], v[32:35]
    v_add_f32 v198, v198, v186
    v_add_f32 v199, v199, v187
    v_add_f32_dpp v188, v188, v188 row_ror:8 row_mask:0xf bank_mask:0xf
    v_mfma_f32_16x16x32_bf16 v[36:39], a[72:75], v[108:111], v[36:39]
    v_add_f32_dpp v189, v189, v189 row_ror:8 row_mask:0xf bank_mask:0xf
    v_add_f32_dpp v190, v190, v190 row_ror:8 row_mask:0xf bank_mask:0xf
    v_add_f32_dpp v191, v191, v191 row_ror:8 row_mask:0xf bank_mask:0xf
    v_mfma_f32_16x16x32_bf16 v[40:43], a[76:79], v[108:111], v[40:43]
    v_add_f32_dpp v192, v192, v192 row_ror:8 row_mask:0xf bank_mask:0xf
    v_add_f32_dpp v193, v193, v193 row_ror:8 row_mask:0xf bank_mask:0xf
    v_add_f32_dpp v194, v194, v194 row_ror:8 row_mask:0xf bank_mask:0xf
    v_mfma_f32_16x16x32_bf16 v[44:47], a[80:83], v[108:111], v[44:47]
    v_add_f32_dpp v195, v195, v195 row_ror:8 row_mask:0xf bank_mask:0xf
    v_add_f32_dpp v196, v196, v196 row_ror:8 row_mask:0xf bank_mask:0xf
    v_cmp_eq_u32 vcc, -1, v170
    s_cbranch_vccnz RTY3
CNT3:
    s_barrier
    s_waitcnt vmcnt(13) lgkmcnt(0)
    v_mfma_f32_16x16x32_bf16 v[200:203], v[208:211], v[112:115], v[200:203]
    ds_read_b64_tr_b16 v[96:97], v132 offset:49152
    v_add_f32_dpp v197, v197, v197 row_ror:8 row_mask:0xf bank_mask:0xf
    v_add_f32_dpp v198, v198, v198 row_ror:8 row_mask:0xf bank_mask:0xf
    v_mfma_f32_16x16x32_bf16 v[204:207], v[112:115], v[112:115], v[204:207]
    ds_read_b64_tr_b16 v[98:99], v132 offset:49664
    s_add_u32 m0, s19, 77824
    s_add_u32 s75, s18, 327808
    v_mfma_f32_16x16x32_bf16 v[0:3], a[84:87], v[112:115], v[0:3]
    ds_read_b64_tr_b16 v[100:101], v133 offset:49152
    buffer_load_dwordx4 v129, s[36:39], s75 offen sc1 lds
    v_add_f32_dpp v199, v199, v199 row_ror:8 row_mask:0xf bank_mask:0xf
    v_mfma_f32_16x16x32_bf16 v[4:7], a[88:91], v[112:115], v[4:7]
    ds_read_b64_tr_b16 v[102:103], v133 offset:49664
    v_add_f32_dpp v188, v188, v188 row_ror:4 row_mask:0xf bank_mask:0xf
    v_add_f32_dpp v189, v189, v189 row_ror:4 row_mask:0xf bank_mask:0xf
    v_mfma_f32_16x16x32_bf16 v[8:11], a[92:95], v[112:115], v[8:11]
    ds_read_b64_tr_b16 v[104:105], v134 offset:49152
    buffer_load_dwordx4 a[132:135], v241, s[36:39], s13 offen offset:0 sc1
    v_add_f32_dpp v190, v190, v190 row_ror:4 row_mask:0xf bank_mask:0xf
    v_mfma_f32_16x16x32_bf16 v[12:15], a[84:87], v[116:119], v[12:15]
    ds_read_b64_tr_b16 v[106:107], v134 offset:49664
    v_add_f32_dpp v191, v191, v191 row_ror:4 row_mask:0xf bank_mask:0xf
    v_add_f32_dpp v192, v192, v192 row_ror:4 row_mask:0xf bank_mask:0xf
    v_mfma_f32_16x16x32_bf16 v[16:19], a[88:91], v[116:119], v[16:19]
    ds_read_b64_tr_b16 v[108:109], v135 offset:49152
    v_add_f32_dpp v193, v193, v193 row_ror:4 row_mask:0xf bank_mask:0xf
    v_add_f32_dpp v194, v194, v194 row_ror:4 row_mask:0xf bank_mask:0xf
    v_mfma_f32_16x16x32_bf16 v[20:23], a[92:95], v[116:119], v[20:23]
    ds_read_b64_tr_b16 v[110:111], v135 offset:49664
    buffer_load_dwordx4 a[136:139], v241, s[36:39], s13 offen offset:1024 sc1
    v_add_f32_dpp v195, v195, v195 row_ror:4 row_mask:0xf bank_mask:0xf
    v_mfma_f32_16x16x32_bf16 v[24:27], a[84:87], v[120:123], v[24:27]
    v_add_f32_dpp v196, v196, v196 row_ror:4 row_mask:0xf bank_mask:0xf
    v_add_f32_dpp v197, v197, v197 row_ror:4 row_mask:0xf bank_mask:0xf
    v_add_f32_dpp v198, v198, v198 row_ror:4 row_mask:0xf bank_mask:0xf
    v_mfma_f32_16x16x32_bf16 v[28:31], a[88:91], v[120:123], v[28:31]
    v_add_f32_dpp v199, v199, v199 row_ror:4 row_mask:0xf bank_mask:0xf
    v_add_f32_dpp v188, v188, v188 row_ror:2 row_mask:0xf bank_mask:0xf
    v_add_f32_dpp v189, v189, v189 row_ror:2 row_mask:0xf bank_mask:0xf
    v_mfma_f32_16x16x32_bf16 v[32:35], a[92:95], v[120:123], v[32:35]
    buffer_load_dwordx4 a[140:143], v241, s[36:39], s13 offen offset:2048 sc1
    s_add_u32 s13, s13, 196608
    v_add_f32_dpp v190, v190, v190 row_ror:2 row_mask:0xf bank_mask:0xf
    v_mfma_f32_16x16x32_bf16 v[36:39], a[84:87], v[124:127], v[36:39]
    v_add_f32_dpp v191, v191, v191 row_ror:2 row_mask:0xf bank_mask:0xf
    v_add_f32_dpp v192, v192, v192 row_ror:2 row_mask:0xf bank_mask:0xf
    v_add_f32_dpp v193, v193, v193 row_ror:2 row_mask:0xf bank_mask:0xf
    v_mfma_f32_16x16x32_bf16 v[40:43], a[88:91], v[124:127], v[40:43]
    v_add_f32_dpp v194, v194, v194 row_ror:2 row_mask:0xf bank_mask:0xf
    v_add_f32_dpp v195, v195, v195 row_ror:2 row_mask:0xf bank_mask:0xf
    v_add_f32_dpp v196, v196, v196 row_ror:2 row_mask:0xf bank_mask:0xf
    v_mfma_f32_16x16x32_bf16 v[44:47], a[92:95], v[124:127], v[44:47]
    v_add_f32_dpp v197, v197, v197 row_ror:2 row_mask:0xf bank_mask:0xf
    v_add_f32_dpp v198, v198, v198 row_ror:2 row_mask:0xf bank_mask:0xf
    s_waitcnt vmcnt(13) lgkmcnt(0)
    s_nop 0
    v_mfma_f32_16x16x32_bf16 v[200:203], v[208:211], v[96:99], v[200:203]
    ds_read_b64_tr_b16 v[112:113], v132 offset:53248
    v_add_f32_dpp v199, v199, v199 row_ror:2 row_mask:0xf bank_mask:0xf
    v_add_f32_dpp v188, v188, v188 row_ror:1 row_mask:0xf bank_mask:0xf
    v_mfma_f32_16x16x32_bf16 v[204:207], v[96:99], v[96:99], v[204:207]
    ds_read_b64_tr_b16 v[114:115], v132 offset:53760
    buffer_load_dwordx4 a[144:147], v241, s[36:39], s13 offen offset:0 sc1
    v_add_f32_dpp v189, v189, v189 row_ror:1 row_mask:0xf bank_mask:0xf
    v_mfma_f32_16x16x32_bf16 v[0:3], a[96:99], v[96:99], v[0:3]
    ds_read_b64_tr_b16 v[116:117], v133 offset:53248
    v_add_f32_dpp v190, v190, v190 row_ror:1 row_mask:0xf bank_mask:0xf
    v_add_f32_dpp v191, v191, v191 row_ror:1 row_mask:0xf bank_mask:0xf
    v_mfma_f32_16x16x32_bf16 v[4:7], a[100:103], v[96:99], v[4:7]
    ds_read_b64_tr_b16 v[118:119], v133 offset:53760
    v_add_f32_dpp v192, v192, v192 row_ror:1 row_mask:0xf bank_mask:0xf
    v_add_f32_dpp v193, v193, v193 row_ror:1 row_mask:0xf bank_mask:0xf
    v_mfma_f32_16x16x32_bf16 v[8:11], a[104:107], v[96:99], v[8:11]
    ds_read_b64_tr_b16 v[120:121], v134 offset:53248
    v_add_f32_dpp v194, v194, v194 row_ror:1 row_mask:0xf bank_mask:0xf
    v_add_f32_dpp v195, v195, v195 row_ror:1 row_mask:0xf bank_mask:0xf
    v_mfma_f32_16x16x32_bf16 v[12:15], a[96:99], v[100:103], v[12:15]
    ds_read_b64_tr_b16 v[122:123], v134 offset:53760
    buffer_load_dwordx4 a[148:151], v241, s[36:39], s13 offen offset:1024 sc1
    v_add_f32_dpp v196, v196, v196 row_ror:1 row_mask:0xf bank_mask:0xf
    v_mfma_f32_16x16x32_bf16 v[16:19], a[100:103], v[100:103], v[16:19]
    ds_read_b64_tr_b16 v[124:125], v135 offset:53248
    v_add_f32_dpp v197, v197, v197 row_ror:1 row_mask:0xf bank_mask:0xf
    v_add_f32_dpp v198, v198, v198 row_ror:1 row_mask:0xf bank_mask:0xf
    v_mfma_f32_16x16x32_bf16 v[20:23], a[104:107], v[100:103], v[20:23]
    ds_read_b64_tr_b16 v[126:127], v135 offset:53760
    v_add_f32_dpp v199, v199, v199 row_ror:1 row_mask:0xf bank_mask:0xf
    s_lshl_b32 s73, s61, 4
    v_mfma_f32_16x16x32_bf16 v[24:27], a[96:99], v[104:107], v[24:27]
    s_add_u32 s73, s73, s62
    s_lshl_b32 s73, s73, 2
    s_add_u32 s73, s73, s3
    v_mfma_f32_16x16x32_bf16 v[28:31], a[100:103], v[104:107], v[28:31]
    buffer_load_dwordx4 a[152:155], v241, s[36:39], s13 offen offset:2048 sc1
    s_add_u32 s13, s13, 196608
    s_lshl_b32 s73, s73, 6
    v_mfma_f32_16x16x32_bf16 v[32:35], a[104:107], v[104:107], v[32:35]
    s_add_u32 s26, s73, 0x40000
    s_add_u32 s27, s73, 0x50000
    s_and_b32 s73, s62, 7
    v_mfma_f32_16x16x32_bf16 v[36:39], a[96:99], v[108:111], v[36:39]
    s_mul_i32 s74, s73, 245760
    s_mul_i32 s73, s3, 61440
    s_add_u32 s74, s74, s73
    v_mfma_f32_16x16x32_bf16 v[40:43], a[100:103], v[108:111], v[40:43]
    s_add_u32 s32, s74, 0xc00000
    s_add_u32 s33, s74, 0xc00800
    s_and_b32 s73, s3, 1
    v_mfma_f32_16x16x32_bf16 v[44:47], a[104:107], v[108:111], v[44:47]
    s_lshl_b32 s73, s73, 11
    v_add_u32 v244, s73, v241
    s_waitcnt vmcnt(13) lgkmcnt(0)
    v_mfma_f32_16x16x32_bf16 v[200:203], v[208:211], v[112:115], v[200:203]
    ds_read_b64_tr_b16 v[96:97], v132 offset:57344
    v_xor_b32 v245, 0x800, v244
    s_and_b32 s73, s62, 7
    v_mfma_f32_16x16x32_bf16 v[204:207], v[112:115], v[112:115], v[204:207]
    ds_read_b64_tr_b16 v[98:99], v132 offset:57856
    buffer_load_dwordx4 a[156:159], v241, s[36:39], s13 offen offset:0 sc1
    s_lshl_b32 s73, s73, 6
    v_mfma_f32_16x16x32_bf16 v[0:3], a[108:111], v[112:115], v[0:3]
    ds_read_b64_tr_b16 v[100:101], v133 offset:57344
    s_add_u32 s31, s73, 0x1000
    v_min_u32 v130, 11, v240
    v_mfma_f32_16x16x32_bf16 v[4:7], a[112:115], v[112:115], v[4:7]
    ds_read_b64_tr_b16 v[102:103], v133 offset:57856
    s_mul_i32 s73, s3, 12
    v_add_u32 v130, s73, v130
    v_mfma_f32_16x16x32_bf16 v[8:11], a[116:119], v[112:115], v[8:11]
    ds_read_b64_tr_b16 v[104:105], v134 offset:57344
    v_lshlrev_b32 v130, 9, v130
    s_lshr_b32 s72, s62, 3
    v_mfma_f32_16x16x32_bf16 v[12:15], a[108:111], v[116:119], v[12:15]
    ds_read_b64_tr_b16 v[106:107], v134 offset:57856
    v_bfe_u32 v162, v240, 1, 2
    s_lshl_b32 s73, s3, 2
    v_mfma_f32_16x16x32_bf16 v[16:19], a[112:115], v[116:119], v[16:19]
    ds_read_b64_tr_b16 v[108:109], v135 offset:57344
    v_add_u32 v162, s73, v162
    v_lshlrev_b32_e64 v162, 2, v162
    v_mfma_f32_16x16x32_bf16 v[20:23], a[116:119], v[116:119], v[20:23]
    ds_read_b64_tr_b16 v[110:111], v135 offset:57856
    buffer_load_dwordx4 a[160:163], v241, s[36:39], s13 offen offset:1024 sc1
    v_and_b32_e64 v163, 1, v240
    v_mfma_f32_16x16x32_bf16 v[24:27], a[108:111], v[120:123], v[24:27]
    s_lshl_b32 s73, s72, 1
    v_add3_u32 v162, v162, v163, s73
    v_lshlrev_b32 v246, 6, v162
    v_mfma_f32_16x16x32_bf16 v[28:31], a[112:115], v[120:123], v[28:31]
    s_lshl_b32 s5, s61, 12
    s_add_u32 s5, s5, 0x40000
    s_lshr_b32 s73, s3, 1
    v_mfma_f32_16x16x32_bf16 v[32:35], a[116:119], v[120:123], v[32:35]
    s_mul_i32 s74, s73, 49152
    v_add_u32 v247, s74, v241
    s_xor_b32 s73, s73, 1
    v_mfma_f32_16x16x32_bf16 v[36:39], a[108:111], v[124:127], v[36:39]
    s_mul_i32 s74, s73, 49152
    v_add_u32 v248, s74, v241
    s_lshl_b32 s73, s61, 2
    v_mfma_f32_16x16x32_bf16 v[40:43], a[112:115], v[124:127], v[40:43]
    s_add_u32 s73, s73, s72
    s_mul_i32 s73, s73, 98304
    s_mul_i32 s74, s3, 12288
    v_mfma_f32_16x16x32_bf16 v[44:47], a[116:119], v[124:127], v[44:47]
    s_add_u32 s73, s73, s74
    s_add_u32 s4, s73, 0xe00000
    s_waitcnt vmcnt(12) lgkmcnt(0)
    v_mfma_f32_16x16x32_bf16 v[200:203], v[208:211], v[96:99], v[200:203]
    ds_read_b64_tr_b16 v[112:113], v132 offset:61440
    s_xor_b32 s73, s3, 1
    s_mul_i32 s73, s73, 6144
    v_mfma_f32_16x16x32_bf16 v[204:207], v[96:99], v[96:99], v[204:207]
    ds_read_b64_tr_b16 v[114:115], v132 offset:61952
    buffer_load_dwordx4 a[164:167], v241, s[36:39], s13 offen offset:2048 sc1
    s_add_u32 s13, s13, 196608
    v_mfma_f32_16x16x32_bf16 v[0:3], a[120:123], v[96:99], v[0:3]
    ds_read_b64_tr_b16 v[116:117], v133 offset:61440
    s_add_u32 s73, s73, 65536
    s_waitcnt vmcnt(9)
    s_nop 0
    ds_read_b32 v170, v252 offset:0
    v_mfma_f32_16x16x32_bf16 v[4:7], a[124:127], v[96:99], v[4:7]
    ds_read_b64_tr_b16 v[118:119], v133 offset:61952
    ds_read_b32 v171, v252 offset:4096
    ds_read_b32 v254, v252 offset:8192
    v_mfma_f32_16x16x32_bf16 v[8:11], a[128:131], v[96:99], v[8:11]
    ds_read_b64_tr_b16 v[120:121], v134 offset:61440
    s_add_u32 m0, s19, 81920
    s_add_u32 s75, s18, 659456
    v_mfma_f32_16x16x32_bf16 v[12:15], a[120:123], v[100:103], v[12:15]
    ds_read_b64_tr_b16 v[122:123], v134 offset:61952
    buffer_load_dwordx4 v129, s[36:39], s75 offen sc1 lds
    ds_read_b32 v251, v252 offset:12288
    v_mfma_f32_16x16x32_bf16 v[16:19], a[124:127], v[100:103], v[16:19]
    ds_read_b64_tr_b16 v[124:125], v135 offset:61440
    v_add_u32 v228, s73, v241
    s_xor_b32 s73, s3, 2
    v_mfma_f32_16x16x32_bf16 v[20:23], a[128:131], v[100:103], v[20:23]
    ds_read_b64_tr_b16 v[126:127], v135 offset:61952
    s_add_u32 m0, s19, 86016
    s_add_u32 s75, s18, 655488
    v_mfma_f32_16x16x32_bf16 v[24:27], a[120:123], v[104:107], v[24:27]
    v_add_u32 v132, 0x10000, v132
    buffer_load_dwordx4 v129, s[36:39], s75 offen sc1 lds
    s_mul_i32 s73, s73, 6144
    v_mfma_f32_16x16x32_bf16 v[28:31], a[124:127], v[104:107], v[28:31]
    v_add_u32 v133, 0x10000, v133
    s_add_u32 s73, s73, 67584
    s_waitcnt lgkmcnt(5)
    s_nop 0
    v_max3_u32 v170, v170, v171, v254
    v_mfma_f32_16x16x32_bf16 v[32:35], a[128:131], v[104:107], v[32:35]
    v_add_u32 v134, 0x10000, v134
    s_add_u32 m0, s19, 90112
    s_add_u32 s75, s18, 987136
    v_mfma_f32_16x16x32_bf16 v[36:39], a[120:123], v[108:111], v[36:39]
    v_add_u32 v135, 0x10000, v135
    buffer_load_dwordx4 v129, s[36:39], s75 offen sc1 lds
    s_waitcnt lgkmcnt(2)
    v_max_u32 v170, v170, v251
    v_mfma_f32_16x16x32_bf16 v[40:43], a[124:127], v[108:111], v[40:43]
    v_add_u32 v229, s73, v241
    s_xor_b32 s73, s3, 3
    s_mul_i32 s73, s73, 6144
    v_mfma_f32_16x16x32_bf16 v[44:47], a[128:131], v[108:111], v[44:47]
    s_add_u32 s73, s73, 69632
    v_add_u32 v230, s73, v241
    v_cmp_eq_u32 vcc, -1, v170
    s_cbranch_vccnz RTY4
CNT4:
    s_barrier
    s_waitcnt vmcnt(9) lgkmcnt(0)
    v_mfma_f32_16x16x32_bf16 v[200:203], v[208:211], v[112:115], v[200:203]
    ds_read_b64_tr_b16 v[96:97], v132 offset:0
    s_lshr_b32 s73, s3, 1
    s_lshl_b32 s73, s73, 12
    s_nop 0
    v_mfma_f32_16x16x32_bf16 v[204:207], v[112:115], v[112:115], v[204:207]
    ds_read_b64_tr_b16 v[98:99], v132 offset:512
    s_add_u32 m0, s19, 94208
    s_add_u32 s75, s18, 983168
    v_mfma_f32_16x16x32_bf16 v[0:3], a[132:135], v[112:115], v[0:3]
    ds_read_b64_tr_b16 v[100:101], v133 offset:0
    buffer_load_dwordx4 v129, s[36:39], s75 offen sc1 lds
    s_add_u32 s73, s73, 90112
    v_mfma_f32_16x16x32_bf16 v[4:7], a[136:139], v[112:115], v[4:7]
    ds_read_b64_tr_b16 v[102:103], v133 offset:512
    v_add_u32 v234, s73, v241
    v_add_u32 v231, s19, v234
    v_mfma_f32_16x16x32_bf16 v[8:11], a[140:143], v[112:115], v[8:11]
    ds_read_b64_tr_b16 v[104:105], v134 offset:0
    v_xor_b32 v232, 0x1000, v231
    s_mul_i32 s73, s3, 6144
    v_mfma_f32_16x16x32_bf16 v[12:15], a[132:135], v[116:119], v[12:15]
    ds_read_b64_tr_b16 v[106:107], v134 offset:512
    buffer_load_dwordx4 a[168:171], v241, s[36:39], s13 offen offset:0 sc1
    s_add_u32 s73, s73, 65536
    v_mfma_f32_16x16x32_bf16 v[16:19], a[136:139], v[116:119], v[16:19]
    ds_read_b64_tr_b16 v[108:109], v135 offset:0
    v_add_u32 v233, s73, v241
    v_lshrrev_b32 v162, 4, v240
    v_mfma_f32_16x16x32_bf16 v[20:23], a[140:143], v[116:119], v[20:23]
    ds_read_b64_tr_b16 v[110:111], v135 offset:512
    v_and_b32 v165, 15, v240
    s_lshl_b32 s72, s72, 1
    v_mfma_f32_16x16x32_bf16 v[24:27], a[132:135], v[120:123], v[24:27]
    s_lshr_b32 s73, s3, 1
    s_add_u32 s72, s72, s73
    s_and_b32 s74, s3, 1
    v_mfma_f32_16x16x32_bf16 v[28:31], a[136:139], v[120:123], v[28:31]
    buffer_load_dwordx4 a[172:175], v241, s[36:39], s13 offen offset:1024 sc1
    s_lshl_b32 s74, s74, 5
    s_lshl_b32 s73, s61, 3
    v_mfma_f32_16x16x32_bf16 v[32:35], a[140:143], v[120:123], v[32:35]
    s_add_u32 s73, s73, s72
    s_mul_i32 s6, s73, 20480
    s_and_b32 s73, s62, 7
    v_mfma_f32_16x16x32_bf16 v[36:39], a[132:135], v[124:127], v[36:39]
    s_mul_i32 s73, s73, 160
    s_add_u32 s6, s6, s73
    v_mul_u32_u24 v165, 1280, v165
    v_mfma_f32_16x16x32_bf16 v[40:43], a[136:139], v[124:127], v[40:43]
    s_lshl_b32 s73, s74, 1
    v_lshl_add_u32 v166, v162, 4, v165
    v_add_u32 v249, s73, v166
    v_mfma_f32_16x16x32_bf16 v[44:47], a[140:143], v[124:127], v[44:47]
    s_and_b32 s73, s3, 1
    s_mul_i32 s73, s73, 0x7ffffff0
    s_waitcnt vmcnt(9) lgkmcnt(0)
    v_mfma_f32_16x16x32_bf16 v[200:203], v[208:211], v[96:99], v[200:203]
    ds_read_b64_tr_b16 v[112:113], v132 offset:4096
    s_add_u32 s73, s73, 128
    v_mfma_f32_16x16x32_bf16 v[204:207], v[96:99], v[96:99], v[204:207]
    ds_read_b64_tr_b16 v[114:115], v132 offset:4608
    buffer_load_dwordx4 a[176:179], v241, s[36:39], s13 offen offset:2048 sc1
    v_mfma_f32_16x16x32_bf16 v[0:3], a[144:147], v[96:99], v[0:3]
    ds_read_b64_tr_b16 v[116:117], v133 offset:4096
    s_add_u32 s13, s13, 196608
    v_mfma_f32_16x16x32_bf16 v[4:7], a[148:151], v[96:99], v[4:7]
    ds_read_b64_tr_b16 v[118:119], v133 offset:4608
    v_lshl_add_u32 v166, v162, 3, v165
    v_mfma_f32_16x16x32_bf16 v[8:11], a[152:155], v[96:99], v[8:11]
    ds_read_b64_tr_b16 v[120:121], v134 offset:4096
    v_add_u32_e64 v250, s73, v166
    v_mfma_f32_16x16x32_bf16 v[12:15], a[144:147], v[100:103], v[12:15]
    ds_read_b64_tr_b16 v[122:123], v134 offset:4608
    buffer_load_dwordx4 a[180:183], v241, s[36:39], s13 offen offset:0 sc1
    v_mfma_f32_16x16x32_bf16 v[16:19], a[148:151], v[100:103], v[16:19]
    ds_read_b64_tr_b16 v[124:125], v135 offset:4096
    v_mfma_f32_16x16x32_bf16 v[20:23], a[152:155], v[100:103], v[20:23]
    ds_read_b64_tr_b16 v[126:127], v135 offset:4608
    v_mfma_f32_16x16x32_bf16 v[24:27], a[144:147], v[104:107], v[24:27]
    v_mfma_f32_16x16x32_bf16 v[28:31], a[148:151], v[104:107], v[28:31]
    buffer_load_dwordx4 a[184:187], v241, s[36:39], s13 offen offset:1024 sc1
    v_mfma_f32_16x16x32_bf16 v[32:35], a[152:155], v[104:107], v[32:35]
    v_mfma_f32_16x16x32_bf16 v[36:39], a[144:147], v[108:111], v[36:39]
    v_mfma_f32_16x16x32_bf16 v[40:43], a[148:151], v[108:111], v[40:43]
    v_mfma_f32_16x16x32_bf16 v[44:47], a[152:155], v[108:111], v[44:47]
    s_waitcnt lgkmcnt(0)
    s_nop 0
    v_mfma_f32_16x16x32_bf16 a[248:251], v[208:211], v[112:115], a[248:251]
    ds_read_b64_tr_b16 v[96:97], v132 offset:8192
    v_mfma_f32_16x16x32_bf16 a[252:255], v[112:115], v[112:115], a[252:255]
    ds_read_b64_tr_b16 v[98:99], v132 offset:8704
    buffer_load_dwordx4 a[188:191], v241, s[36:39], s13 offen offset:2048 sc1
    v_mfma_f32_16x16x32_bf16 v[48:51], a[48:51], v[112:115], v[48:51]
    ds_read_b64_tr_b16 v[100:101], v133 offset:8192
    s_add_u32 s13, s13, 196608
    v_mfma_f32_16x16x32_bf16 v[52:55], a[52:55], v[112:115], v[52:55]
    ds_read_b64_tr_b16 v[102:103], v133 offset:8704
    v_mfma_f32_16x16x32_bf16 v[56:59], a[56:59], v[112:115], v[56:59]
    ds_read_b64_tr_b16 v[104:105], v134 offset:8192
    v_mfma_f32_16x16x32_bf16 v[60:63], a[48:51], v[116:119], v[60:63]
    ds_read_b64_tr_b16 v[106:107], v134 offset:8704
    s_add_u32 m0, s19, 98304
    v_mfma_f32_16x16x32_bf16 v[64:67], a[52:55], v[116:119], v[64:67]
    ds_read_b64_tr_b16 v[108:109], v135 offset:8192
    s_add_u32 s75, s18, 1314816
    v_mfma_f32_16x16x32_bf16 v[68:71], a[56:59], v[116:119], v[68:71]
    ds_read_b64_tr_b16 v[110:111], v135 offset:8704
    buffer_load_dwordx4 v129, s[36:39], s75 offen sc1 lds
    v_mfma_f32_16x16x32_bf16 v[72:75], a[48:51], v[120:123], v[72:75]
    v_mfma_f32_16x16x32_bf16 v[76:79], a[52:55], v[120:123], v[76:79]
    s_add_u32 m0, s19, 102400
    s_add_u32 s75, s18, 1310848
    v_mfma_f32_16x16x32_bf16 v[80:83], a[56:59], v[120:123], v[80:83]
    buffer_load_dwordx4 v129, s[36:39], s75 offen sc1 lds
    v_mfma_f32_16x16x32_bf16 v[84:87], a[48:51], v[124:127], v[84:87]
    v_mfma_f32_16x16x32_bf16 v[88:91], a[52:55], v[124:127], v[88:91]
    v_mfma_f32_16x16x32_bf16 v[92:95], a[56:59], v[124:127], v[92:95]
    s_waitcnt vmcnt(12) lgkmcnt(0)
    v_mfma_f32_16x16x32_bf16 v[200:203], v[208:211], v[96:99], v[200:203]
    ds_read_b64_tr_b16 v[112:113], v132 offset:12288
    s_waitcnt vmcnt(8)
    ds_read_b32 v170, v252 offset:16384
    v_mfma_f32_16x16x32_bf16 v[204:207], v[96:99], v[96:99], v[204:207]
    ds_read_b64_tr_b16 v[114:115], v132 offset:12800
    s_add_u32 m0, s19, 106496
    v_mfma_f32_16x16x32_bf16 v[0:3], a[156:159], v[96:99], v[0:3]
    ds_read_b64_tr_b16 v[116:117], v133 offset:12288
    s_add_u32 s75, s18, 1642496
    v_mfma_f32_16x16x32_bf16 v[4:7], a[160:163], v[96:99], v[4:7]
    ds_read_b64_tr_b16 v[118:119], v133 offset:12800
    buffer_load_dwordx4 v129, s[36:39], s75 offen sc1 lds
    v_mfma_f32_16x16x32_bf16 v[8:11], a[164:167], v[96:99], v[8:11]
    ds_read_b64_tr_b16 v[120:121], v134 offset:12288
    s_add_u32 m0, s19, 110592
    v_mfma_f32_16x16x32_bf16 v[12:15], a[156:159], v[100:103], v[12:15]
    ds_read_b64_tr_b16 v[122:123], v134 offset:12800
    s_add_u32 s75, s18, 1638528
    v_mfma_f32_16x16x32_bf16 v[16:19], a[160:163], v[100:103], v[16:19]
    ds_read_b64_tr_b16 v[124:125], v135 offset:12288
    buffer_load_dwordx4 v129, s[36:39], s75 offen sc1 lds
    v_mfma_f32_16x16x32_bf16 v[20:23], a[164:167], v[100:103], v[20:23]
    ds_read_b64_tr_b16 v[126:127], v135 offset:12800
    buffer_load_dwordx4 a[192:195], v241, s[36:39], s13 offen offset:0 sc1
    v_mfma_f32_16x16x32_bf16 v[24:27], a[156:159], v[104:107], v[24:27]
    ds_read_b32 v171, v252 offset:20480
    ds_read_b32 v254, v252 offset:24576
    v_mfma_f32_16x16x32_bf16 v[28:31], a[160:163], v[104:107], v[28:31]
    ds_read_b32 v251, v252 offset:28672
    s_nop 0
    v_mfma_f32_16x16x32_bf16 v[32:35], a[164:167], v[104:107], v[32:35]
    buffer_load_dword v255, v130, s[36:39], s31 offen sc1
    s_nop 0
    v_mfma_f32_16x16x32_bf16 v[36:39], a[156:159], v[108:111], v[36:39]
    s_nop 0
    s_nop 0
    v_mfma_f32_16x16x32_bf16 v[40:43], a[160:163], v[108:111], v[40:43]
    s_waitcnt lgkmcnt(1)
    v_max3_u32 v170, v170, v171, v254
    s_waitcnt lgkmcnt(0)
    v_max_u32_e64 v170, v170, v251
    v_mfma_f32_16x16x32_bf16 v[44:47], a[164:167], v[108:111], v[44:47]
    v_cmp_eq_u32 vcc, -1, v170
    s_cbranch_vccnz RTY5
CNT5:
    s_barrier
    s_nop 0
    v_mfma_f32_16x16x32_bf16 a[248:251], v[208:211], v[112:115], a[248:251]
    ds_read_b64_tr_b16 v[96:97], v132 offset:16384
    v_mfma_f32_16x16x32_bf16 a[252:255], v[112:115], v[112:115], a[252:255]
    ds_read_b64_tr_b16 v[98:99], v132 offset:16896
    buffer_load_dwordx4 a[196:199], v241, s[36:39], s13 offen offset:1024 sc1
    v_mfma_f32_16x16x32_bf16 v[48:51], a[60:63], v[112:115], v[48:51]
    ds_read_b64_tr_b16 v[100:101], v133 offset:16384
    v_mfma_f32_16x16x32_bf16 v[52:55], a[64:67], v[112:115], v[52:55]
    ds_read_b64_tr_b16 v[102:103], v133 offset:16896
    v_mfma_f32_16x16x32_bf16 v[56:59], a[68:71], v[112:115], v[56:59]
    ds_read_b64_tr_b16 v[104:105], v134 offset:16384
    buffer_load_dwordx4 a[200:203], v241, s[36:39], s13 offen offset:2048 sc1
    v_mfma_f32_16x16x32_bf16 v[60:63], a[60:63], v[116:119], v[60:63]
    ds_read_b64_tr_b16 v[106:107], v134 offset:16896
    s_add_u32 s13, s13, 196608
    v_mfma_f32_16x16x32_bf16 v[64:67], a[64:67], v[116:119], v[64:67]
    ds_read_b64_tr_b16 v[108:109], v135 offset:16384
    v_mfma_f32_16x16x32_bf16 v[68:71], a[68:71], v[116:119], v[68:71]
    ds_read_b64_tr_b16 v[110:111], v135 offset:16896
    buffer_load_dwordx4 a[204:207], v241, s[36:39], s13 offen offset:0 sc1
    v_mfma_f32_16x16x32_bf16 v[72:75], a[60:63], v[120:123], v[72:75]
    v_mfma_f32_16x16x32_bf16 v[76:79], a[64:67], v[120:123], v[76:79]
    v_mfma_f32_16x16x32_bf16 v[80:83], a[68:71], v[120:123], v[80:83]
    buffer_load_dwordx4 a[208:211], v241, s[36:39], s13 offen offset:1024 sc1
    v_mfma_f32_16x16x32_bf16 v[84:87], a[60:63], v[124:127], v[84:87]
    v_mfma_f32_16x16x32_bf16 v[88:91], a[64:67], v[124:127], v[88:91]
    v_mfma_f32_16x16x32_bf16 v[92:95], a[68:71], v[124:127], v[92:95]
    s_waitcnt vmcnt(13) lgkmcnt(0)
    s_nop 0
    v_mfma_f32_16x16x32_bf16 v[200:203], v[208:211], v[96:99], v[200:203]
    ds_read_b64_tr_b16 v[112:113], v132 offset:20480
    v_mfma_f32_16x16x32_bf16 v[204:207], v[96:99], v[96:99], v[204:207]
    ds_read_b64_tr_b16 v[114:115], v132 offset:20992
    buffer_load_dwordx4 a[212:215], v241, s[36:39], s13 offen offset:2048 sc1
    v_mfma_f32_16x16x32_bf16 v[0:3], a[168:171], v[96:99], v[0:3]
    ds_read_b64_tr_b16 v[116:117], v133 offset:20480
    s_add_u32 s13, s13, 196608
    v_mfma_f32_16x16x32_bf16 v[4:7], a[172:175], v[96:99], v[4:7]
    ds_read_b64_tr_b16 v[118:119], v133 offset:20992
    v_mfma_f32_16x16x32_bf16 v[8:11], a[176:179], v[96:99], v[8:11]
    ds_read_b64_tr_b16 v[120:121], v134 offset:20480
    v_mfma_f32_16x16x32_bf16 v[12:15], a[168:171], v[100:103], v[12:15]
    ds_read_b64_tr_b16 v[122:123], v134 offset:20992
    s_add_u32 m0, s19, 114688
    v_mfma_f32_16x16x32_bf16 v[16:19], a[172:175], v[100:103], v[16:19]
    ds_read_b64_tr_b16 v[124:125], v135 offset:20480
    s_add_u32 s75, s18, 1970176
    v_mfma_f32_16x16x32_bf16 v[20:23], a[176:179], v[100:103], v[20:23]
    ds_read_b64_tr_b16 v[126:127], v135 offset:20992
    buffer_load_dwordx4 v129, s[36:39], s75 offen sc1 lds
    v_mfma_f32_16x16x32_bf16 v[24:27], a[168:171], v[104:107], v[24:27]
    v_mfma_f32_16x16x32_bf16 v[28:31], a[172:175], v[104:107], v[28:31]
    s_add_u32 m0, s19, 118784
    s_add_u32 s75, s18, 1966208
    v_mfma_f32_16x16x32_bf16 v[32:35], a[176:179], v[104:107], v[32:35]
    buffer_load_dwordx4 v129, s[36:39], s75 offen sc1 lds
    v_mfma_f32_16x16x32_bf16 v[36:39], a[168:171], v[108:111], v[36:39]
    v_mfma_f32_16x16x32_bf16 v[40:43], a[172:175], v[108:111], v[40:43]
    v_mfma_f32_16x16x32_bf16 v[44:47], a[176:179], v[108:111], v[44:47]
    s_waitcnt lgkmcnt(0)
    s_nop 0
    v_mfma_f32_16x16x32_bf16 a[248:251], v[208:211], v[112:115], a[248:251]
    ds_read_b64_tr_b16 v[96:97], v132 offset:24576
    v_mfma_f32_16x16x32_bf16 a[252:255], v[112:115], v[112:115], a[252:255]
    ds_read_b64_tr_b16 v[98:99], v132 offset:25088
    s_add_u32 m0, s19, 122880
    v_mfma_f32_16x16x32_bf16 v[48:51], a[72:75], v[112:115], v[48:51]
    ds_read_b64_tr_b16 v[100:101], v133 offset:24576
    s_add_u32 s75, s18, 2297856
    v_mfma_f32_16x16x32_bf16 v[52:55], a[76:79], v[112:115], v[52:55]
    ds_read_b64_tr_b16 v[102:103], v133 offset:25088
    buffer_load_dwordx4 v129, s[36:39], s75 offen sc1 lds
    v_mfma_f32_16x16x32_bf16 v[56:59], a[80:83], v[112:115], v[56:59]
    ds_read_b64_tr_b16 v[104:105], v134 offset:24576
    v_mfma_f32_16x16x32_bf16 v[60:63], a[72:75], v[116:119], v[60:63]
    ds_read_b64_tr_b16 v[106:107], v134 offset:25088
    s_add_u32 m0, s19, 126976
    v_mfma_f32_16x16x32_bf16 v[64:67], a[76:79], v[116:119], v[64:67]
    ds_read_b64_tr_b16 v[108:109], v135 offset:24576
    s_add_u32 s75, s18, 2293888
    v_mfma_f32_16x16x32_bf16 v[68:71], a[80:83], v[116:119], v[68:71]
    ds_read_b64_tr_b16 v[110:111], v135 offset:25088
    buffer_load_dwordx4 v129, s[36:39], s75 offen sc1 lds
    v_mfma_f32_16x16x32_bf16 v[72:75], a[72:75], v[120:123], v[72:75]
    v_mfma_f32_16x16x32_bf16 v[76:79], a[76:79], v[120:123], v[76:79]
    buffer_load_dwordx4 a[216:219], v241, s[36:39], s13 offen offset:0 sc1
    v_mfma_f32_16x16x32_bf16 v[80:83], a[80:83], v[120:123], v[80:83]
    v_mfma_f32_16x16x32_bf16 v[84:87], a[72:75], v[124:127], v[84:87]
    v_mfma_f32_16x16x32_bf16 v[88:91], a[76:79], v[124:127], v[88:91]
    v_mfma_f32_16x16x32_bf16 v[92:95], a[80:83], v[124:127], v[92:95]
    s_mov_b32 s70, 0
    s_waitcnt vmcnt(10)
    v_cmp_ne_u32 vcc, s56, v255
    s_cbranch_vccz POLLD1
POLL1:
    buffer_load_dword v255, v130, s[36:39], s31 offen sc1
    s_add_u32 s70, s70, 1
    s_cmp_gt_u32 s70, 200000
    s_waitcnt vmcnt(0)
    s_cbranch_scc1 POLLD1
    v_cmp_ne_u32 vcc, s56, v255
    s_cbranch_vccnz POLL1
POLLD1:
    s_waitcnt lgkmcnt(0)
    v_mfma_f32_16x16x32_bf16 v[200:203], v[208:211], v[96:99], v[200:203]
    ds_read_b64_tr_b16 v[112:113], v132 offset:28672
    ds_read_b32 v170, v252 offset:32768
    v_mfma_f32_16x16x32_bf16 v[204:207], v[96:99], v[96:99], v[204:207]
    ds_read_b64_tr_b16 v[114:115], v132 offset:29184
    buffer_load_dwordx4 a[220:223], v241, s[36:39], s13 offen offset:1024 sc1
    v_mfma_f32_16x16x32_bf16 v[0:3], a[180:183], v[96:99], v[0:3]
    ds_read_b64_tr_b16 v[116:117], v133 offset:28672
    ds_read_b32 v171, v252 offset:36864
    v_mfma_f32_16x16x32_bf16 v[4:7], a[184:187], v[96:99], v[4:7]
    ds_read_b64_tr_b16 v[118:119], v133 offset:29184
    ds_read_b32 v254, v252 offset:40960
    v_mfma_f32_16x16x32_bf16 v[8:11], a[188:191], v[96:99], v[8:11]
    ds_read_b64_tr_b16 v[120:121], v134 offset:28672
    ds_read_b32 v251, v252 offset:45056
    v_mfma_f32_16x16x32_bf16 v[12:15], a[180:183], v[100:103], v[12:15]
    ds_read_b64_tr_b16 v[122:123], v134 offset:29184
    buffer_load_dwordx4 a[224:227], v241, s[36:39], s13 offen offset:2048 sc1
    v_mfma_f32_16x16x32_bf16 v[16:19], a[184:187], v[100:103], v[16:19]
    ds_read_b64_tr_b16 v[124:125], v135 offset:28672
    s_add_u32 s13, s13, 196608
    v_mfma_f32_16x16x32_bf16 v[20:23], a[188:191], v[100:103], v[20:23]
    ds_read_b64_tr_b16 v[126:127], v135 offset:29184
    s_nop 0
    v_mfma_f32_16x16x32_bf16 v[24:27], a[180:183], v[104:107], v[24:27]
    s_nop 0
    s_nop 0
    v_mfma_f32_16x16x32_bf16 v[28:31], a[184:187], v[104:107], v[28:31]
    buffer_load_dwordx4 a[228:231], v241, s[36:39], s13 offen offset:0 sc1
    s_nop 0
    v_mfma_f32_16x16x32_bf16 v[32:35], a[188:191], v[104:107], v[32:35]
    s_waitcnt lgkmcnt(5)
    v_max3_u32 v170, v170, v171, v254
    s_waitcnt lgkmcnt(3)
    v_max_u32_e64 v170, v170, v251
    v_mfma_f32_16x16x32_bf16 v[36:39], a[180:183], v[108:111], v[36:39]
    v_mfma_f32_16x16x32_bf16 v[40:43], a[184:187], v[108:111], v[40:43]
    v_mfma_f32_16x16x32_bf16 v[44:47], a[188:191], v[108:111], v[44:47]
    v_cmp_eq_u32 vcc, -1, v170
    s_cbranch_vccnz RTY6
CNT6:
    s_barrier
    s_waitcnt lgkmcnt(0)
    v_mfma_f32_16x16x32_bf16 a[248:251], v[208:211], v[112:115], a[248:251]
    ds_read_b64_tr_b16 v[96:97], v132 offset:32768
    v_mfma_f32_16x16x32_bf16 a[252:255], v[112:115], v[112:115], a[252:255]
    ds_read_b64_tr_b16 v[98:99], v132 offset:33280
    buffer_load_dwordx4 a[232:235], v241, s[36:39], s13 offen offset:1024 sc1
    v_mfma_f32_16x16x32_bf16 v[48:51], a[84:87], v[112:115], v[48:51]
    ds_read_b64_tr_b16 v[100:101], v133 offset:32768
    v_mfma_f32_16x16x32_bf16 v[52:55], a[88:91], v[112:115], v[52:55]
    ds_read_b64_tr_b16 v[102:103], v133 offset:33280
    v_mfma_f32_16x16x32_bf16 v[56:59], a[92:95], v[112:115], v[56:59]
    ds_read_b64_tr_b16 v[104:105], v134 offset:32768
    v_mfma_f32_16x16x32_bf16 v[60:63], a[84:87], v[116:119], v[60:63]
    ds_read_b64_tr_b16 v[106:107], v134 offset:33280
    buffer_load_dwordx4 a[236:239], v241, s[36:39], s13 offen offset:2048 sc1
    v_mfma_f32_16x16x32_bf16 v[64:67], a[88:91], v[116:119], v[64:67]
    ds_read_b64_tr_b16 v[108:109], v135 offset:32768
    s_add_u32 s13, s13, 196608
    v_mfma_f32_16x16x32_bf16 v[68:71], a[92:95], v[116:119], v[68:71]
    ds_read_b64_tr_b16 v[110:111], v135 offset:33280
    v_mfma_f32_16x16x32_bf16 v[72:75], a[84:87], v[120:123], v[72:75]
    v_mfma_f32_16x16x32_bf16 v[76:79], a[88:91], v[120:123], v[76:79]
    s_add_u32 m0, s19, 131072
    s_add_u32 s75, s18, 4224
    v_mfma_f32_16x16x32_bf16 v[80:83], a[92:95], v[120:123], v[80:83]
    buffer_load_dwordx4 v129, s[36:39], s75 offen sc1 lds
    v_mfma_f32_16x16x32_bf16 v[84:87], a[84:87], v[124:127], v[84:87]
    v_mfma_f32_16x16x32_bf16 v[88:91], a[88:91], v[124:127], v[88:91]
    v_mfma_f32_16x16x32_bf16 v[92:95], a[92:95], v[124:127], v[92:95]
    s_waitcnt vmcnt(14) lgkmcnt(0)
    s_nop 0
    v_mfma_f32_16x16x32_bf16 v[200:203], v[208:211], v[96:99], v[200:203]
    ds_read_b64_tr_b16 v[112:113], v132 offset:36864
    v_mfma_f32_16x16x32_bf16 v[204:207], v[96:99], v[96:99], v[204:207]
    ds_read_b64_tr_b16 v[114:115], v132 offset:37376
    s_add_u32 m0, s19, 135168
    v_mfma_f32_16x16x32_bf16 v[0:3], a[192:195], v[96:99], v[0:3]
    ds_read_b64_tr_b16 v[116:117], v133 offset:36864
    s_add_u32 s75, s18, 331904
    v_mfma_f32_16x16x32_bf16 v[4:7], a[196:199], v[96:99], v[4:7]
    ds_read_b64_tr_b16 v[118:119], v133 offset:37376
    buffer_load_dwordx4 v129, s[36:39], s75 offen sc1 lds
    v_mfma_f32_16x16x32_bf16 v[8:11], a[200:203], v[96:99], v[8:11]
    ds_read_b64_tr_b16 v[120:121], v134 offset:36864
    s_add_u32 m0, s19, 139264
    v_mfma_f32_16x16x32_bf16 v[12:15], a[192:195], v[100:103], v[12:15]
    ds_read_b64_tr_b16 v[122:123], v134 offset:37376
    s_add_u32 s75, s18, 659584
    v_mfma_f32_16x16x32_bf16 v[16:19], a[196:199], v[100:103], v[16:19]
    ds_read_b64_tr_b16 v[124:125], v135 offset:36864
    buffer_load_dwordx4 v129, s[36:39], s75 offen sc1 lds
    v_mfma_f32_16x16x32_bf16 v[20:23], a[200:203], v[100:103], v[20:23]
    ds_read_b64_tr_b16 v[126:127], v135 offset:37376
    s_add_u32 m0, s19, 143360
    v_mfma_f32_16x16x32_bf16 v[24:27], a[192:195], v[104:107], v[24:27]
    s_add_u32 s75, s18, 987264
    buffer_load_dwordx4 v129, s[36:39], s75 offen sc1 lds
    v_mfma_f32_16x16x32_bf16 v[28:31], a[196:199], v[104:107], v[28:31]
    v_mfma_f32_16x16x32_bf16 v[32:35], a[200:203], v[104:107], v[32:35]
    s_add_u32 m0, s19, 147456
    s_add_u32 s75, s18, 1314944
    v_mfma_f32_16x16x32_bf16 v[36:39], a[192:195], v[108:111], v[36:39]
    buffer_load_dwordx4 v129, s[36:39], s75 offen sc1 lds
    v_mfma_f32_16x16x32_bf16 v[40:43], a[196:199], v[108:111], v[40:43]
    v_mfma_f32_16x16x32_bf16 v[44:47], a[200:203], v[108:111], v[44:47]
    s_waitcnt lgkmcnt(0)
    s_nop 0
    v_mfma_f32_16x16x32_bf16 a[248:251], v[208:211], v[112:115], a[248:251]
    ds_read_b64_tr_b16 v[96:97], v132 offset:40960
    v_mfma_f32_16x16x32_bf16 a[252:255], v[112:115], v[112:115], a[252:255]
    ds_read_b64_tr_b16 v[98:99], v132 offset:41472
    s_add_u32 m0, s19, 151552
    v_mfma_f32_16x16x32_bf16 v[48:51], a[96:99], v[112:115], v[48:51]
    ds_read_b64_tr_b16 v[100:101], v133 offset:40960
    s_add_u32 s75, s18, 1642624
    v_mfma_f32_16x16x32_bf16 v[52:55], a[100:103], v[112:115], v[52:55]
    ds_read_b64_tr_b16 v[102:103], v133 offset:41472
    buffer_load_dwordx4 v129, s[36:39], s75 offen sc1 lds
    v_mfma_f32_16x16x32_bf16 v[56:59], a[104:107], v[112:115], v[56:59]
    ds_read_b64_tr_b16 v[104:105], v134 offset:40960
    v_mfma_f32_16x16x32_bf16 v[60:63], a[96:99], v[116:119], v[60:63]
    ds_read_b64_tr_b16 v[106:107], v134 offset:41472
    s_add_u32 m0, s19, 155648
    v_mfma_f32_16x16x32_bf16 v[64:67], a[100:103], v[116:119], v[64:67]
    ds_read_b64_tr_b16 v[108:109], v135 offset:40960
    s_add_u32 s75, s18, 1970304
    v_mfma_f32_16x16x32_bf16 v[68:71], a[104:107], v[116:119], v[68:71]
    ds_read_b64_tr_b16 v[110:111], v135 offset:41472
    buffer_load_dwordx4 v129, s[36:39], s75 offen sc1 lds
    v_mfma_f32_16x16x32_bf16 v[72:75], a[96:99], v[120:123], v[72:75]
    v_mfma_f32_16x16x32_bf16 v[76:79], a[100:103], v[120:123], v[76:79]
    s_add_u32 m0, s19, 159744
    s_add_u32 s75, s18, 2297984
    v_mfma_f32_16x16x32_bf16 v[80:83], a[104:107], v[120:123], v[80:83]
    buffer_load_dwordx4 v129, s[36:39], s75 offen sc1 lds
    v_mfma_f32_16x16x32_bf16 v[84:87], a[96:99], v[124:127], v[84:87]
    v_mfma_f32_16x16x32_bf16 v[88:91], a[100:103], v[124:127], v[88:91]
    v_mfma_f32_16x16x32_bf16 v[92:95], a[104:107], v[124:127], v[92:95]
    s_waitcnt vmcnt(18) lgkmcnt(0)
    v_mfma_f32_16x16x32_bf16 v[200:203], v[208:211], v[96:99], v[200:203]
    ds_read_b64_tr_b16 v[112:113], v132 offset:45056
    s_waitcnt vmcnt(14)
    ds_read_b32 v170, v252 offset:49152
    v_mfma_f32_16x16x32_bf16 v[204:207], v[96:99], v[96:99], v[204:207]
    ds_read_b64_tr_b16 v[114:115], v132 offset:45568
    buffer_load_dwordx4 a[0:3], v244, s[36:39], s32 offen offset:0 sc1
    v_mfma_f32_16x16x32_bf16 v[0:3], a[204:207], v[96:99], v[0:3]
    ds_read_b64_tr_b16 v[116:117], v133 offset:45056
    ds_read_b32 v171, v252 offset:53248
    v_mfma_f32_16x16x32_bf16 v[4:7], a[208:211], v[96:99], v[4:7]
    ds_read_b64_tr_b16 v[118:119], v133 offset:45568
    ds_read_b32 v254, v252 offset:57344
    v_mfma_f32_16x16x32_bf16 v[8:11], a[212:215], v[96:99], v[8:11]
    ds_read_b64_tr_b16 v[120:121], v134 offset:45056
    ds_read_b32 v251, v252 offset:61440
    v_mfma_f32_16x16x32_bf16 v[12:15], a[204:207], v[100:103], v[12:15]
    ds_read_b64_tr_b16 v[122:123], v134 offset:45568
    buffer_load_dwordx4 a[4:7], v244, s[36:39], s32 offen offset:1024 sc1
    v_mfma_f32_16x16x32_bf16 v[16:19], a[208:211], v[100:103], v[16:19]
    ds_read_b64_tr_b16 v[124:125], v135 offset:45056
    s_nop 0
    v_mfma_f32_16x16x32_bf16 v[20:23], a[212:215], v[100:103], v[20:23]
    ds_read_b64_tr_b16 v[126:127], v135 offset:45568
    s_nop 0
    v_mfma_f32_16x16x32_bf16 v[24:27], a[204:207], v[104:107], v[24:27]
    s_nop 0
    s_nop 0
    v_mfma_f32_16x16x32_bf16 v[28:31], a[208:211], v[104:107], v[28:31]
    buffer_load_dwordx4 a[8:11], v245, s[36:39], s32 offen offset:0 sc1
    s_waitcnt lgkmcnt(5)
    v_max3_u32 v170, v170, v171, v254
    v_mfma_f32_16x16x32_bf16 v[32:35], a[212:215], v[104:107], v[32:35]
    s_waitcnt lgkmcnt(3)
    v_max_u32_e64 v170, v170, v251
    v_mfma_f32_16x16x32_bf16 v[36:39], a[204:207], v[108:111], v[36:39]
    v_mfma_f32_16x16x32_bf16 v[40:43], a[208:211], v[108:111], v[40:43]
    v_mfma_f32_16x16x32_bf16 v[44:47], a[212:215], v[108:111], v[44:47]
    v_cmp_eq_u32 vcc, -1, v170
    s_cbranch_vccnz RTY7
CNT7:
    s_barrier
    s_waitcnt lgkmcnt(0)
    v_mfma_f32_16x16x32_bf16 a[248:251], v[208:211], v[112:115], a[248:251]
    ds_read_b64_tr_b16 v[96:97], v132 offset:49152
    v_mfma_f32_16x16x32_bf16 a[252:255], v[112:115], v[112:115], a[252:255]
    ds_read_b64_tr_b16 v[98:99], v132 offset:49664
    buffer_load_dwordx4 a[12:15], v245, s[36:39], s32 offen offset:1024 sc1
    v_mfma_f32_16x16x32_bf16 v[48:51], a[108:111], v[112:115], v[48:51]
    ds_read_b64_tr_b16 v[100:101], v133 offset:49152
    v_mfma_f32_16x16x32_bf16 v[52:55], a[112:115], v[112:115], v[52:55]
    ds_read_b64_tr_b16 v[102:103], v133 offset:49664
    v_mfma_f32_16x16x32_bf16 v[56:59], a[116:119], v[112:115], v[56:59]
    ds_read_b64_tr_b16 v[104:105], v134 offset:49152
    v_mfma_f32_16x16x32_bf16 v[60:63], a[108:111], v[116:119], v[60:63]
    ds_read_b64_tr_b16 v[106:107], v134 offset:49664
    buffer_load_dwordx4 a[16:19], v241, s[36:39], s33 offen offset:2048 sc1
    v_mfma_f32_16x16x32_bf16 v[64:67], a[112:115], v[116:119], v[64:67]
    ds_read_b64_tr_b16 v[108:109], v135 offset:49152
    s_add_u32 s32, s32, 5120
    v_mfma_f32_16x16x32_bf16 v[68:71], a[116:119], v[116:119], v[68:71]
    ds_read_b64_tr_b16 v[110:111], v135 offset:49664
    s_add_u32 s33, s33, 5120
    v_mfma_f32_16x16x32_bf16 v[72:75], a[108:111], v[120:123], v[72:75]
    v_mfma_f32_16x16x32_bf16 v[76:79], a[112:115], v[120:123], v[76:79]
    buffer_load_dwordx4 a[20:23], v244, s[36:39], s32 offen offset:0 sc1
    v_mfma_f32_16x16x32_bf16 v[80:83], a[116:119], v[120:123], v[80:83]
    v_mfma_f32_16x16x32_bf16 v[84:87], a[108:111], v[124:127], v[84:87]
    v_mfma_f32_16x16x32_bf16 v[88:91], a[112:115], v[124:127], v[88:91]
    v_mfma_f32_16x16x32_bf16 v[92:95], a[116:119], v[124:127], v[92:95]
    s_waitcnt vmcnt(17) lgkmcnt(0)
    s_nop 0
    v_mfma_f32_16x16x32_bf16 v[200:203], v[208:211], v[96:99], v[200:203]
    ds_read_b64_tr_b16 v[112:113], v132 offset:53248
    v_mfma_f32_16x16x32_bf16 v[204:207], v[96:99], v[96:99], v[204:207]
    ds_read_b64_tr_b16 v[114:115], v132 offset:53760
    buffer_load_dwordx4 a[24:27], v244, s[36:39], s32 offen offset:1024 sc1
    v_mfma_f32_16x16x32_bf16 v[0:3], a[216:219], v[96:99], v[0:3]
    ds_read_b64_tr_b16 v[116:117], v133 offset:53248
    v_mfma_f32_16x16x32_bf16 v[4:7], a[220:223], v[96:99], v[4:7]
    ds_read_b64_tr_b16 v[118:119], v133 offset:53760
    v_mfma_f32_16x16x32_bf16 v[8:11], a[224:227], v[96:99], v[8:11]
    ds_read_b64_tr_b16 v[120:121], v134 offset:53248
    v_mfma_f32_16x16x32_bf16 v[12:15], a[216:219], v[100:103], v[12:15]
    ds_read_b64_tr_b16 v[122:123], v134 offset:53760
    buffer_load_dwordx4 a[28:31], v245, s[36:39], s32 offen offset:0 sc1
    v_mfma_f32_16x16x32_bf16 v[16:19], a[220:223], v[100:103], v[16:19]
    ds_read_b64_tr_b16 v[124:125], v135 offset:53248
    v_mfma_f32_16x16x32_bf16 v[20:23], a[224:227], v[100:103], v[20:23]
    ds_read_b64_tr_b16 v[126:127], v135 offset:53760
    v_mfma_f32_16x16x32_bf16 v[24:27], a[216:219], v[104:107], v[24:27]
    v_mfma_f32_16x16x32_bf16 v[28:31], a[220:223], v[104:107], v[28:31]
    buffer_load_dwordx4 a[32:35], v245, s[36:39], s32 offen offset:1024 sc1
    v_mfma_f32_16x16x32_bf16 v[32:35], a[224:227], v[104:107], v[32:35]
    v_mfma_f32_16x16x32_bf16 v[36:39], a[216:219], v[108:111], v[36:39]
    v_mfma_f32_16x16x32_bf16 v[40:43], a[220:223], v[108:111], v[40:43]
    v_mfma_f32_16x16x32_bf16 v[44:47], a[224:227], v[108:111], v[44:47]
    s_waitcnt lgkmcnt(0)
    s_nop 0
    v_mfma_f32_16x16x32_bf16 a[248:251], v[208:211], v[112:115], a[248:251]
    ds_read_b64_tr_b16 v[96:97], v132 offset:57344
    v_mfma_f32_16x16x32_bf16 a[252:255], v[112:115], v[112:115], a[252:255]
    ds_read_b64_tr_b16 v[98:99], v132 offset:57856
    buffer_load_dwordx4 a[36:39], v241, s[36:39], s33 offen offset:2048 sc1
    v_mfma_f32_16x16x32_bf16 v[48:51], a[120:123], v[112:115], v[48:51]
    ds_read_b64_tr_b16 v[100:101], v133 offset:57344
    s_add_u32 s32, s32, 5120
    v_mfma_f32_16x16x32_bf16 v[52:55], a[124:127], v[112:115], v[52:55]
    ds_read_b64_tr_b16 v[102:103], v133 offset:57856
    s_add_u32 s33, s33, 5120
    v_mfma_f32_16x16x32_bf16 v[56:59], a[128:131], v[112:115], v[56:59]
    ds_read_b64_tr_b16 v[104:105], v134 offset:57344
    buffer_load_dwordx4 a[40:43], v244, s[36:39], s32 offen offset:0 sc1
    v_mfma_f32_16x16x32_bf16 v[60:63], a[120:123], v[116:119], v[60:63]
    ds_read_b64_tr_b16 v[106:107], v134 offset:57856
    v_mfma_f32_16x16x32_bf16 v[64:67], a[124:127], v[116:119], v[64:67]
    ds_read_b64_tr_b16 v[108:109], v135 offset:57344
    v_mfma_f32_16x16x32_bf16 v[68:71], a[128:131], v[116:119], v[68:71]
    ds_read_b64_tr_b16 v[110:111], v135 offset:57856
    buffer_load_dwordx4 a[44:47], v244, s[36:39], s32 offen offset:1024 sc1
    v_mfma_f32_16x16x32_bf16 v[72:75], a[120:123], v[120:123], v[72:75]
    v_mfma_f32_16x16x32_bf16 v[76:79], a[124:127], v[120:123], v[76:79]
    v_mfma_f32_16x16x32_bf16 v[80:83], a[128:131], v[120:123], v[80:83]
    buffer_load_dwordx4 a[48:51], v245, s[36:39], s32 offen offset:0 sc1
    v_mfma_f32_16x16x32_bf16 v[84:87], a[120:123], v[124:127], v[84:87]
    v_mfma_f32_16x16x32_bf16 v[88:91], a[124:127], v[124:127], v[88:91]
    v_mfma_f32_16x16x32_bf16 v[92:95], a[128:131], v[124:127], v[92:95]
    s_waitcnt vmcnt(21) lgkmcnt(0)
    v_mfma_f32_16x16x32_bf16 v[200:203], v[208:211], v[96:99], v[200:203]
    ds_read_b64_tr_b16 v[176:177], v138
    s_nop 0
    v_mfma_f32_16x16x32_bf16 v[204:207], v[96:99], v[96:99], v[204:207]
    ds_read_b64_tr_b16 v[178:179], v139
    buffer_load_dwordx4 a[52:55], v245, s[36:39], s32 offen offset:1024 sc1
    v_mfma_f32_16x16x32_bf16 v[0:3], a[228:231], v[96:99], v[0:3]
    ds_read_b64_tr_b16 v[180:181], v140
    s_nop 0
    v_mfma_f32_16x16x32_bf16 v[4:7], a[232:235], v[96:99], v[4:7]
    ds_read_b64_tr_b16 v[112:113], v132 offset:61440
    s_nop 0
    v_mfma_f32_16x16x32_bf16 v[8:11], a[236:239], v[96:99], v[8:11]
    ds_read_b64_tr_b16 v[114:115], v132 offset:61952
    s_waitcnt vmcnt(18)
    s_nop 0
    ds_read_b32 v170, v253 offset:0
    v_mfma_f32_16x16x32_bf16 v[12:15], a[228:231], v[100:103], v[12:15]
    ds_read_b64_tr_b16 v[116:117], v133 offset:61440
    buffer_load_dwordx4 a[56:59], v241, s[36:39], s33 offen offset:2048 sc1
    v_mfma_f32_16x16x32_bf16 v[16:19], a[232:235], v[100:103], v[16:19]
    ds_read_b64_tr_b16 v[118:119], v133 offset:61952
    s_add_u32 s32, s32, 5120
    v_mfma_f32_16x16x32_bf16 v[20:23], a[236:239], v[100:103], v[20:23]
    ds_read_b64_tr_b16 v[120:121], v134 offset:61440
    s_add_u32 s33, s33, 5120
    v_mfma_f32_16x16x32_bf16 v[24:27], a[228:231], v[104:107], v[24:27]
    ds_read_b64_tr_b16 v[122:123], v134 offset:61952
    ds_read_b32 v171, v253 offset:4096
    v_mfma_f32_16x16x32_bf16 v[28:31], a[232:235], v[104:107], v[28:31]
    ds_read_b64_tr_b16 v[124:125], v135 offset:61440
    buffer_load_dwordx4 a[60:63], v244, s[36:39], s32 offen offset:0 sc1
    v_mfma_f32_16x16x32_bf16 v[32:35], a[236:239], v[104:107], v[32:35]
    ds_read_b64_tr_b16 v[126:127], v135 offset:61952
    ds_read_b32 v254, v253 offset:8192
    v_mfma_f32_16x16x32_bf16 v[36:39], a[228:231], v[108:111], v[36:39]
    v_add_u32 v132, 0x10000, v132
    ds_read_b32 v251, v253 offset:12288
    v_mfma_f32_16x16x32_bf16 v[40:43], a[232:235], v[108:111], v[40:43]
    v_add_u32 v133, 0x10000, v133
    v_mul_f32 v212, 0xbacccccd, v200
    v_mfma_f32_16x16x32_bf16 v[44:47], a[236:239], v[108:111], v[44:47]
    v_add_u32 v134, 0x10000, v134
    v_add_u32 v135, 0x10000, v135
    v_cndmask_b32 v160, v204, v205, s[66:67]
    v_cndmask_b32 v161, v206, v207, s[66:67]
    v_cndmask_b32 v160, v160, v161, s[68:69]
    s_waitcnt lgkmcnt(1)
    v_max3_u32 v170, v170, v171, v254
    s_waitcnt lgkmcnt(0)
    v_max_u32 v170, v170, v251
    v_cmp_eq_u32 vcc, -1, v170
    s_cbranch_vccnz RTY8
CNT8:
    s_barrier
    s_barrier
    ds_write_b32 v142, v212 offset:0
    ds_write_b32 v143, v160 offset:0
    v_mfma_f32_16x16x32_bf16 a[248:251], v[208:211], v[112:115], a[248:251]
    ds_read_b64_tr_b16 v[96:97], v132 offset:0
    s_nop 0
    s_waitcnt lgkmcnt(1)
    s_barrier
    v_mfma_f32_16x16x32_bf16 a[252:255], v[112:115], v[112:115], a[252:255]
    ds_read_b64_tr_b16 v[98:99], v132 offset:512
    buffer_load_dwordx4 a[64:67], v244, s[36:39], s32 offen offset:1024 sc1
    v_xor_b32 v144, 128, v142
    v_mfma_f32_16x16x32_bf16 v[48:51], a[132:135], v[112:115], v[48:51]
    ds_read_b64_tr_b16 v[100:101], v133 offset:0
    ds_read_b32 v213, v144 offset:0
    v_xor_b32 v144, 256, v142
    v_mfma_f32_16x16x32_bf16 v[52:55], a[136:139], v[112:115], v[52:55]
    ds_read_b64_tr_b16 v[102:103], v133 offset:512
    ds_read_b32 v214, v144 offset:0
    v_xor_b32 v144, 384, v142
    v_mfma_f32_16x16x32_bf16 v[56:59], a[140:143], v[112:115], v[56:59]
    ds_read_b64_tr_b16 v[104:105], v134 offset:0
    ds_read_b32 v215, v144 offset:0
    ds_read2_b32 v[172:173], v145 offset0:0 offset1:16
    v_mfma_f32_16x16x32_bf16 v[60:63], a[132:135], v[116:119], v[60:63]
    ds_read_b64_tr_b16 v[106:107], v134 offset:512
    buffer_load_dwordx4 a[68:71], v245, s[36:39], s32 offen offset:0 sc1
    v_fma_f32 v0, v212, v188, v0
    v_mfma_f32_16x16x32_bf16 v[64:67], a[136:139], v[116:119], v[64:67]
    ds_read_b64_tr_b16 v[108:109], v135 offset:0
    v_fma_f32 v1, v212, v189, v1
    v_fma_f32 v2, v212, v190, v2
    v_mfma_f32_16x16x32_bf16 v[68:71], a[140:143], v[116:119], v[68:71]
    ds_read_b64_tr_b16 v[110:111], v135 offset:512
    v_fma_f32 v3, v212, v191, v3
    v_fma_f32 v4, v212, v192, v4
    v_mfma_f32_16x16x32_bf16 v[72:75], a[132:135], v[120:123], v[72:75]
    v_fma_f32 v5, v212, v193, v5
    v_fma_f32 v6, v212, v194, v6
    v_fma_f32 v7, v212, v195, v7
    v_mfma_f32_16x16x32_bf16 v[76:79], a[136:139], v[120:123], v[76:79]
    buffer_load_dwordx4 a[72:75], v245, s[36:39], s32 offen offset:1024 sc1
    v_fma_f32 v8, v212, v196, v8
    v_fma_f32 v9, v212, v197, v9
    v_mfma_f32_16x16x32_bf16 v[80:83], a[140:143], v[120:123], v[80:83]
    v_fma_f32 v10, v212, v198, v10
    v_fma_f32 v11, v212, v199, v11
    v_max_f32_e64 v0, 0, v0
    v_mfma_f32_16x16x32_bf16 v[84:87], a[132:135], v[124:127], v[84:87]
    v_max_f32 v1, 0, v1
    v_max_f32 v4, 0, v4
    v_max_f32_e64 v5, 0, v5
    v_mfma_f32_16x16x32_bf16 v[88:91], a[136:139], v[124:127], v[88:91]
    v_max_f32 v8, 0, v8
    v_max_f32 v9, 0, v9
    v_mul_f32_e64 v0, v0, v2
    v_mfma_f32_16x16x32_bf16 v[92:95], a[140:143], v[124:127], v[92:95]
    v_mul_f32 v1, v1, v3
    v_mul_f32 v4, v4, v6
    s_waitcnt lgkmcnt(0)
    v_mfma_f32_16x16x32_bf16 a[248:251], v[208:211], v[96:99], a[248:251]
    ds_read_b64_tr_b16 v[112:113], v132 offset:4096
    v_mul_f32 v5, v5, v7
    v_mul_f32_e64 v8, v8, v10
    v_mfma_f32_16x16x32_bf16 a[252:255], v[96:99], v[96:99], a[252:255]
    ds_read_b64_tr_b16 v[114:115], v132 offset:4608
    buffer_load_dwordx4 a[76:79], v241, s[36:39], s33 offen offset:2048 sc1
    s_add_u32 s32, s32, 5120
    v_mfma_f32_16x16x32_bf16 v[48:51], a[144:147], v[96:99], v[48:51]
    ds_read_b64_tr_b16 v[116:117], v133 offset:4096
    s_add_u32 s33, s33, 5120
    v_mul_f32_e64 v9, v9, v11
    v_mfma_f32_16x16x32_bf16 v[52:55], a[148:151], v[96:99], v[52:55]
    ds_read_b64_tr_b16 v[118:119], v133 offset:4608
    v_cvt_pk_bf16_f32 v0, v0, v1
    v_cvt_pk_bf16_f32 v4, v4, v5
    v_mfma_f32_16x16x32_bf16 v[56:59], a[152:155], v[96:99], v[56:59]
    ds_read_b64_tr_b16 v[120:121], v134 offset:4096
    v_cvt_pk_bf16_f32 v8, v8, v9
    ds_write_b32 v216, v0 offset:32768
    v_mfma_f32_16x16x32_bf16 v[60:63], a[144:147], v[100:103], v[60:63]
    ds_read_b64_tr_b16 v[122:123], v134 offset:4608
    buffer_load_dwordx4 a[80:83], v244, s[36:39], s32 offen offset:0 sc1
    ds_write_b32 v217, v4 offset:32768
    v_mfma_f32_16x16x32_bf16 v[64:67], a[148:151], v[100:103], v[64:67]
    ds_read_b64_tr_b16 v[124:125], v135 offset:4096
    ds_write_b32 v218, v8 offset:32768
    v_fma_f32 v12, v213, v188, v12
    v_mfma_f32_16x16x32_bf16 v[68:71], a[152:155], v[100:103], v[68:71]
    ds_read_b64_tr_b16 v[126:127], v135 offset:4608
    v_fma_f32 v13, v213, v189, v13
    v_fma_f32 v14, v213, v190, v14
    v_mfma_f32_16x16x32_bf16 v[72:75], a[144:147], v[104:107], v[72:75]
    v_fma_f32 v15, v213, v191, v15
    v_fma_f32 v16, v213, v192, v16
    v_fma_f32 v17, v213, v193, v17
    v_mfma_f32_16x16x32_bf16 v[76:79], a[148:151], v[104:107], v[76:79]
    buffer_load_dwordx4 a[84:87], v244, s[36:39], s32 offen offset:1024 sc1
    v_fma_f32 v18, v213, v194, v18
    v_fma_f32 v19, v213, v195, v19
    v_mfma_f32_16x16x32_bf16 v[80:83], a[152:155], v[104:107], v[80:83]
    v_fma_f32 v20, v213, v196, v20
    v_fma_f32 v21, v213, v197, v21
    v_fma_f32 v22, v213, v198, v22
    v_mfma_f32_16x16x32_bf16 v[84:87], a[144:147], v[108:111], v[84:87]
    v_fma_f32 v23, v213, v199, v23
    v_max_f32 v12, 0, v12
    v_max_f32 v13, 0, v13
    v_mfma_f32_16x16x32_bf16 v[88:91], a[148:151], v[108:111], v[88:91]
    v_max_f32 v16, 0, v16
    v_max_f32 v17, 0, v17
    v_max_f32_e64 v20, 0, v20
    v_mfma_f32_16x16x32_bf16 v[92:95], a[152:155], v[108:111], v[92:95]
    v_max_f32 v21, 0, v21
    v_mul_f32 v12, v12, v14
    s_waitcnt lgkmcnt(0)
    v_mfma_f32_16x16x32_bf16 a[248:251], v[208:211], v[112:115], a[248:251]
    ds_read_b64_tr_b16 v[96:97], v132 offset:8192
    v_mul_f32 v13, v13, v15
    v_mul_f32_e64 v16, v16, v18
    v_mfma_f32_16x16x32_bf16 a[252:255], v[112:115], v[112:115], a[252:255]
    ds_read_b64_tr_b16 v[98:99], v132 offset:8704
    buffer_load_dwordx4 a[88:91], v245, s[36:39], s32 offen offset:0 sc1
    v_mul_f32_e64 v17, v17, v19
    v_mfma_f32_16x16x32_bf16 v[48:51], a[156:159], v[112:115], v[48:51]
    ds_read_b64_tr_b16 v[100:101], v133 offset:8192
    v_mul_f32 v20, v20, v22
    v_mul_f32 v21, v21, v23
    v_mfma_f32_16x16x32_bf16 v[52:55], a[160:163], v[112:115], v[52:55]
    ds_read_b64_tr_b16 v[102:103], v133 offset:8704
    v_cvt_pk_bf16_f32 v12, v12, v13
    v_cvt_pk_bf16_f32 v16, v16, v17
    v_mfma_f32_16x16x32_bf16 v[56:59], a[164:167], v[112:115], v[56:59]
    ds_read_b64_tr_b16 v[104:105], v134 offset:8192
    v_cvt_pk_bf16_f32 v20, v20, v21
    ds_write_b32 v219, v12 offset:32768
    v_mfma_f32_16x16x32_bf16 v[60:63], a[156:159], v[116:119], v[60:63]
    ds_read_b64_tr_b16 v[106:107], v134 offset:8704
    buffer_load_dwordx4 a[92:95], v245, s[36:39], s32 offen offset:1024 sc1
    ds_write_b32 v220, v16 offset:32768
    v_mfma_f32_16x16x32_bf16 v[64:67], a[160:163], v[116:119], v[64:67]
    ds_read_b64_tr_b16 v[108:109], v135 offset:8192
    ds_write_b32 v221, v20 offset:32768
    v_fma_f32 v24, v214, v188, v24
    v_mfma_f32_16x16x32_bf16 v[68:71], a[164:167], v[116:119], v[68:71]
    ds_read_b64_tr_b16 v[110:111], v135 offset:8704
    v_fma_f32 v25, v214, v189, v25
    v_fma_f32 v26, v214, v190, v26
    v_mfma_f32_16x16x32_bf16 v[72:75], a[156:159], v[120:123], v[72:75]
    v_fma_f32 v27, v214, v191, v27
    v_fma_f32 v28, v214, v192, v28
    v_fma_f32 v29, v214, v193, v29
    v_mfma_f32_16x16x32_bf16 v[76:79], a[160:163], v[120:123], v[76:79]
    buffer_load_dwordx4 a[96:99], v241, s[36:39], s33 offen offset:2048 sc1
    s_add_u32 s32, s32, 5120
    s_add_u32 s33, s33, 5120
    v_mfma_f32_16x16x32_bf16 v[80:83], a[164:167], v[120:123], v[80:83]
    v_fma_f32 v30, v214, v194, v30
    v_fma_f32 v31, v214, v195, v31
    v_fma_f32 v32, v214, v196, v32
    v_mfma_f32_16x16x32_bf16 v[84:87], a[156:159], v[124:127], v[84:87]
    v_fma_f32 v33, v214, v197, v33
    v_fma_f32 v34, v214, v198, v34
    v_fma_f32 v35, v214, v199, v35
    v_mfma_f32_16x16x32_bf16 v[88:91], a[160:163], v[124:127], v[88:91]
    v_max_f32 v24, 0, v24
    v_max_f32 v25, 0, v25
    v_max_f32_e64 v28, 0, v28
    v_mfma_f32_16x16x32_bf16 v[92:95], a[164:167], v[124:127], v[92:95]
    v_max_f32 v29, 0, v29
    v_max_f32 v32, 0, v32
    s_waitcnt lgkmcnt(0)
    v_mfma_f32_16x16x32_bf16 a[248:251], v[208:211], v[96:99], a[248:251]
    ds_read_b64_tr_b16 v[112:113], v132 offset:12288
    v_max_f32 v33, 0, v33
    v_mul_f32_e64 v24, v24, v26
    v_mfma_f32_16x16x32_bf16 a[252:255], v[96:99], v[96:99], a[252:255]
    ds_read_b64_tr_b16 v[114:115], v132 offset:12800
    buffer_load_dwordx4 a[100:103], v244, s[36:39], s32 offen offset:0 sc1
    v_mul_f32_e64 v25, v25, v27
    v_mfma_f32_16x16x32_bf16 v[48:51], a[168:171], v[96:99], v[48:51]
    ds_read_b64_tr_b16 v[116:117], v133 offset:12288
    s_waitcnt vmcnt(26)
    s_nop 0
    ds_read_b32 v170, v253 offset:16384
    ds_read_b32 v171, v253 offset:20480
    v_mfma_f32_16x16x32_bf16 v[52:55], a[172:175], v[96:99], v[52:55]
    ds_read_b64_tr_b16 v[118:119], v133 offset:12800
    ds_read_b32 v254, v253 offset:24576
    ds_read_b32 v251, v253 offset:28672
    v_mfma_f32_16x16x32_bf16 v[56:59], a[176:179], v[96:99], v[56:59]
    ds_read_b64_tr_b16 v[120:121], v134 offset:12288
    buffer_load_dwordx4 a[104:107], v244, s[36:39], s32 offen offset:1024 sc1
    v_mul_f32_e64 v28, v28, v30
    v_mfma_f32_16x16x32_bf16 v[60:63], a[168:171], v[100:103], v[60:63]
    ds_read_b64_tr_b16 v[122:123], v134 offset:12800
    v_mul_f32 v29, v29, v31
    v_mul_f32 v32, v32, v34
    v_mfma_f32_16x16x32_bf16 v[64:67], a[172:175], v[100:103], v[64:67]
    ds_read_b64_tr_b16 v[124:125], v135 offset:12288
    v_mul_f32 v33, v33, v35
    s_waitcnt lgkmcnt(4)
    v_max3_u32 v170, v170, v171, v254
    v_mfma_f32_16x16x32_bf16 v[68:71], a[176:179], v[100:103], v[68:71]
    ds_read_b64_tr_b16 v[126:127], v135 offset:12800
    buffer_load_dwordx4 a[108:111], v245, s[36:39], s32 offen offset:0 sc1
    s_waitcnt lgkmcnt(4)
    v_max_u32 v170, v170, v251
    v_mfma_f32_16x16x32_bf16 v[72:75], a[168:171], v[104:107], v[72:75]
    v_cvt_pk_bf16_f32 v24, v24, v25
    v_cvt_pk_bf16_f32 v28, v28, v29
    v_cvt_pk_bf16_f32 v32, v32, v33
    v_mfma_f32_16x16x32_bf16 v[76:79], a[172:175], v[104:107], v[76:79]
    ds_write_b32 v222, v24 offset:32768
    ds_write_b32 v223, v28 offset:32768
    ds_write_b32 v224, v32 offset:32768
    v_mfma_f32_16x16x32_bf16 v[80:83], a[176:179], v[104:107], v[80:83]
    buffer_load_dwordx4 a[112:115], v245, s[36:39], s32 offen offset:1024 sc1
    v_fma_f32 v36, v215, v188, v36
    v_fma_f32 v37, v215, v189, v37
    v_mfma_f32_16x16x32_bf16 v[84:87], a[168:171], v[108:111], v[84:87]
    v_fma_f32 v38, v215, v190, v38
    v_fma_f32 v39, v215, v191, v39
    v_fma_f32 v40, v215, v192, v40
    v_mfma_f32_16x16x32_bf16 v[88:91], a[172:175], v[108:111], v[88:91]
    v_fma_f32 v41, v215, v193, v41
    v_fma_f32 v42, v215, v194, v42
    v_fma_f32 v43, v215, v195, v43
    v_mfma_f32_16x16x32_bf16 v[92:95], a[176:179], v[108:111], v[92:95]
    v_fma_f32 v44, v215, v196, v44
    v_fma_f32 v45, v215, v197, v45
    v_cmp_eq_u32 vcc, -1, v170
    s_cbranch_vccnz RTY9
CNT9:
    s_barrier
    s_waitcnt lgkmcnt(3)
    v_mfma_f32_16x16x32_bf16 a[248:251], v[208:211], v[112:115], a[248:251]
    ds_read_b64_tr_b16 v[96:97], v132 offset:16384
    v_fma_f32 v46, v215, v198, v46
    v_fma_f32 v47, v215, v199, v47
    v_mfma_f32_16x16x32_bf16 a[252:255], v[112:115], v[112:115], a[252:255]
    ds_read_b64_tr_b16 v[98:99], v132 offset:16896
    buffer_load_dwordx4 a[116:119], v241, s[36:39], s33 offen offset:2048 sc1
    s_add_u32 s32, s32, 5120
    v_mfma_f32_16x16x32_bf16 v[48:51], a[180:183], v[112:115], v[48:51]
    ds_read_b64_tr_b16 v[100:101], v133 offset:16384
    s_add_u32 s33, s33, 5120
    v_max_f32_e64 v36, 0, v36
    v_mfma_f32_16x16x32_bf16 v[52:55], a[184:187], v[112:115], v[52:55]
    ds_read_b64_tr_b16 v[102:103], v133 offset:16896
    v_max_f32 v37, 0, v37
    v_max_f32 v40, 0, v40
    v_mfma_f32_16x16x32_bf16 v[56:59], a[188:191], v[112:115], v[56:59]
    ds_read_b64_tr_b16 v[104:105], v134 offset:16384
    v_max_f32 v41, 0, v41
    v_max_f32 v44, 0, v44
    v_mfma_f32_16x16x32_bf16 v[60:63], a[180:183], v[116:119], v[60:63]
    ds_read_b64_tr_b16 v[106:107], v134 offset:16896
    buffer_load_dwordx4 a[120:123], v244, s[36:39], s32 offen offset:0 sc1
    v_max_f32_e64 v45, 0, v45
    v_mfma_f32_16x16x32_bf16 v[64:67], a[184:187], v[116:119], v[64:67]
    ds_read_b64_tr_b16 v[108:109], v135 offset:16384
    v_mul_f32 v36, v36, v38
    v_mul_f32 v37, v37, v39
    v_mfma_f32_16x16x32_bf16 v[68:71], a[188:191], v[116:119], v[68:71]
    ds_read_b64_tr_b16 v[110:111], v135 offset:16896
    v_mul_f32 v40, v40, v42
    v_mul_f32 v41, v41, v43
    v_mfma_f32_16x16x32_bf16 v[72:75], a[180:183], v[120:123], v[72:75]
    v_mul_f32 v44, v44, v46
    v_mul_f32 v45, v45, v47
    v_cvt_pk_bf16_f32 v36, v36, v37
    v_mfma_f32_16x16x32_bf16 v[76:79], a[184:187], v[120:123], v[76:79]
    buffer_load_dwordx4 a[124:127], v244, s[36:39], s32 offen offset:1024 sc1
    v_cvt_pk_bf16_f32 v40, v40, v41
    v_cvt_pk_bf16_f32 v44, v44, v45
    v_mfma_f32_16x16x32_bf16 v[80:83], a[188:191], v[120:123], v[80:83]
    ds_write_b32 v225, v36 offset:32768
    ds_write_b32 v226, v40 offset:32768
    ds_write_b32 v227, v44 offset:32768
    v_mfma_f32_16x16x32_bf16 v[84:87], a[180:183], v[124:127], v[84:87]
    s_waitcnt lgkmcnt(0)
    s_barrier
    ds_read2st64_b32 v[148:149], v141 offset0:128 offset1:129
    ds_read2st64_b32 v[150:151], v141 offset0:130 offset1:131
    v_mfma_f32_16x16x32_bf16 v[88:91], a[184:187], v[124:127], v[88:91]
    ds_read2st64_b32 v[152:153], v141 offset0:144 offset1:145
    ds_read2st64_b32 v[154:155], v141 offset0:146 offset1:147
    ds_read2st64_b32 v[156:157], v141 offset0:160 offset1:161
    v_mfma_f32_16x16x32_bf16 v[92:95], a[188:191], v[124:127], v[92:95]
    ds_read2st64_b32 v[158:159], v141 offset0:162 offset1:163
    s_nop 0
    v_mfma_f32_16x16x32_bf16 a[248:251], v[208:211], v[96:99], a[248:251]
    ds_read_b64_tr_b16 v[112:113], v132 offset:20480
    s_nop 0
    s_nop 0
    v_mfma_f32_16x16x32_bf16 a[252:255], v[96:99], v[96:99], a[252:255]
    ds_read_b64_tr_b16 v[114:115], v132 offset:20992
    buffer_load_dwordx4 a[128:131], v245, s[36:39], s32 offen offset:0 sc1
    s_nop 0
    v_mfma_f32_16x16x32_bf16 v[48:51], a[192:195], v[96:99], v[48:51]
    ds_read_b64_tr_b16 v[116:117], v133 offset:20480
    s_waitcnt lgkmcnt(7)
    buffer_store_dwordx4 v[148:151], v241, s[36:39], s24 offen offset:0 sc1
    s_waitcnt lgkmcnt(5)
    buffer_store_dwordx4 v[152:155], v241, s[36:39], s24 offen offset:1024 sc1
    v_mfma_f32_16x16x32_bf16 v[52:55], a[196:199], v[96:99], v[52:55]
    ds_read_b64_tr_b16 v[118:119], v133 offset:20992
    s_waitcnt lgkmcnt(4)
    s_nop 0
    buffer_store_dwordx4 v[156:159], v241, s[36:39], s24 offen offset:2048 sc1
    v_mfma_f32_16x16x32_bf16 v[56:59], a[200:203], v[96:99], v[56:59]
    ds_read_b64_tr_b16 v[120:121], v134 offset:20480
    v_mfma_f32_16x16x32_bf16 v[60:63], a[192:195], v[100:103], v[60:63]
    ds_read_b64_tr_b16 v[122:123], v134 offset:20992
    buffer_load_dwordx4 a[132:135], v245, s[36:39], s32 offen offset:1024 sc1
    v_mfma_f32_16x16x32_bf16 v[64:67], a[196:199], v[100:103], v[64:67]
    ds_read_b64_tr_b16 v[124:125], v135 offset:20480
    v_mfma_f32_16x16x32_bf16 v[68:71], a[200:203], v[100:103], v[68:71]
    ds_read_b64_tr_b16 v[126:127], v135 offset:20992
    v_mfma_f32_16x16x32_bf16 v[72:75], a[192:195], v[104:107], v[72:75]
    v_mfma_f32_16x16x32_bf16 v[76:79], a[196:199], v[104:107], v[76:79]
    buffer_load_dwordx4 a[136:139], v241, s[36:39], s33 offen offset:2048 sc1
    s_add_u32 s32, s32, 5120
    s_add_u32 s33, s33, 5120
    v_mfma_f32_16x16x32_bf16 v[80:83], a[200:203], v[104:107], v[80:83]
    v_mfma_f32_16x16x32_bf16 v[84:87], a[192:195], v[108:111], v[84:87]
    v_mfma_f32_16x16x32_bf16 v[88:91], a[196:199], v[108:111], v[88:91]
    v_mfma_f32_16x16x32_bf16 v[92:95], a[200:203], v[108:111], v[92:95]
    s_waitcnt lgkmcnt(0)
    s_nop 0
    v_mfma_f32_16x16x32_bf16 a[248:251], v[208:211], v[112:115], a[248:251]
    ds_read_b64_tr_b16 v[96:97], v132 offset:24576
    v_mfma_f32_16x16x32_bf16 a[252:255], v[112:115], v[112:115], a[252:255]
    ds_read_b64_tr_b16 v[98:99], v132 offset:25088
    buffer_load_dwordx4 a[140:143], v244, s[36:39], s32 offen offset:0 sc1
    v_mfma_f32_16x16x32_bf16 v[48:51], a[204:207], v[112:115], v[48:51]
    ds_read_b64_tr_b16 v[100:101], v133 offset:24576
    v_mfma_f32_16x16x32_bf16 v[52:55], a[208:211], v[112:115], v[52:55]
    ds_read_b64_tr_b16 v[102:103], v133 offset:25088
    v_mfma_f32_16x16x32_bf16 v[56:59], a[212:215], v[112:115], v[56:59]
    ds_read_b64_tr_b16 v[104:105], v134 offset:24576
    v_mfma_f32_16x16x32_bf16 v[60:63], a[204:207], v[116:119], v[60:63]
    ds_read_b64_tr_b16 v[106:107], v134 offset:25088
    buffer_load_dwordx4 a[144:147], v244, s[36:39], s32 offen offset:1024 sc1
    v_mfma_f32_16x16x32_bf16 v[64:67], a[208:211], v[116:119], v[64:67]
    ds_read_b64_tr_b16 v[108:109], v135 offset:24576
    v_mfma_f32_16x16x32_bf16 v[68:71], a[212:215], v[116:119], v[68:71]
    ds_read_b64_tr_b16 v[110:111], v135 offset:25088
    v_mfma_f32_16x16x32_bf16 v[72:75], a[204:207], v[120:123], v[72:75]
    v_mfma_f32_16x16x32_bf16 v[76:79], a[208:211], v[120:123], v[76:79]
    buffer_load_dwordx4 a[148:151], v245, s[36:39], s32 offen offset:0 sc1
    v_mfma_f32_16x16x32_bf16 v[80:83], a[212:215], v[120:123], v[80:83]
    v_mfma_f32_16x16x32_bf16 v[84:87], a[204:207], v[124:127], v[84:87]
    v_mfma_f32_16x16x32_bf16 v[88:91], a[208:211], v[124:127], v[88:91]
    v_mfma_f32_16x16x32_bf16 v[92:95], a[212:215], v[124:127], v[92:95]
    s_waitcnt lgkmcnt(0)
    s_nop 0
    v_mfma_f32_16x16x32_bf16 a[248:251], v[208:211], v[96:99], a[248:251]
    ds_read_b64_tr_b16 v[112:113], v132 offset:28672
    v_mfma_f32_16x16x32_bf16 a[252:255], v[96:99], v[96:99], a[252:255]
    ds_read_b64_tr_b16 v[114:115], v132 offset:29184
    buffer_load_dwordx4 a[152:155], v245, s[36:39], s32 offen offset:1024 sc1
    v_mfma_f32_16x16x32_bf16 v[48:51], a[216:219], v[96:99], v[48:51]
    ds_read_b64_tr_b16 v[116:117], v133 offset:28672
    v_mfma_f32_16x16x32_bf16 v[52:55], a[220:223], v[96:99], v[52:55]
    ds_read_b64_tr_b16 v[118:119], v133 offset:29184
    v_mfma_f32_16x16x32_bf16 v[56:59], a[224:227], v[96:99], v[56:59]
    ds_read_b64_tr_b16 v[120:121], v134 offset:28672
    v_mfma_f32_16x16x32_bf16 v[60:63], a[216:219], v[100:103], v[60:63]
    ds_read_b64_tr_b16 v[122:123], v134 offset:29184
    buffer_load_dwordx4 a[156:159], v241, s[36:39], s33 offen offset:2048 sc1
    s_add_u32 s32, s32, 5120
    v_mfma_f32_16x16x32_bf16 v[64:67], a[220:223], v[100:103], v[64:67]
    ds_read_b64_tr_b16 v[124:125], v135 offset:28672
    s_add_u32 s33, s33, 5120
    v_mfma_f32_16x16x32_bf16 v[68:71], a[224:227], v[100:103], v[68:71]
    ds_read_b64_tr_b16 v[126:127], v135 offset:29184
    v_mfma_f32_16x16x32_bf16 v[72:75], a[216:219], v[104:107], v[72:75]
    v_mfma_f32_16x16x32_bf16 v[76:79], a[220:223], v[104:107], v[76:79]
    buffer_load_dwordx4 a[160:163], v244, s[36:39], s32 offen offset:0 sc1
    v_mfma_f32_16x16x32_bf16 v[80:83], a[224:227], v[104:107], v[80:83]
    v_mfma_f32_16x16x32_bf16 v[84:87], a[216:219], v[108:111], v[84:87]
    v_mfma_f32_16x16x32_bf16 v[88:91], a[220:223], v[108:111], v[88:91]
    v_mfma_f32_16x16x32_bf16 v[92:95], a[224:227], v[108:111], v[92:95]
    s_waitcnt lgkmcnt(0)
    v_mfma_f32_16x16x32_bf16 a[248:251], v[208:211], v[112:115], a[248:251]
    ds_read_b64_tr_b16 v[182:183], v146
    s_nop 0
    s_nop 0
    v_mfma_f32_16x16x32_bf16 a[252:255], v[112:115], v[112:115], a[252:255]
    ds_read_b64_tr_b16 v[184:185], v147
    buffer_load_dwordx4 a[164:167], v244, s[36:39], s32 offen offset:1024 sc1
    s_nop 0
    v_mfma_f32_16x16x32_bf16 v[48:51], a[228:231], v[112:115], v[48:51]
    ds_read_b64_tr_b16 v[186:187], v235
    s_nop 0
    s_nop 0
    v_accvgpr_read_b32 v200, a248
    v_mfma_f32_16x16x32_bf16 v[52:55], a[232:235], v[112:115], v[52:55]
    v_accvgpr_read_b32 v204, a252
    v_accvgpr_read_b32 v205, a253
    v_accvgpr_read_b32 v206, a254
    v_mfma_f32_16x16x32_bf16 v[56:59], a[236:239], v[112:115], v[56:59]
    buffer_load_dwordx4 a[168:171], v245, s[36:39], s32 offen offset:0 sc1
    v_accvgpr_read_b32 v207, a255
    v_mul_f32 v212, 0xbacccccd, v200
    v_mfma_f32_16x16x32_bf16 v[60:63], a[228:231], v[116:119], v[60:63]
    v_cndmask_b32 v160, v204, v205, s[66:67]
    v_cndmask_b32 v161, v206, v207, s[66:67]
    v_cndmask_b32 v160, v160, v161, s[68:69]
    v_mfma_f32_16x16x32_bf16 v[64:67], a[232:235], v[116:119], v[64:67]
    ds_write_b32 v142, v212 offset:512
    ds_write_b32 v143, v160 offset:512
    v_mfma_f32_16x16x32_bf16 v[68:71], a[236:239], v[116:119], v[68:71]
    buffer_load_dwordx4 a[172:175], v245, s[36:39], s32 offen offset:1024 sc1
    v_mfma_f32_16x16x32_bf16 v[72:75], a[228:231], v[120:123], v[72:75]
    v_mfma_f32_16x16x32_bf16 v[76:79], a[232:235], v[120:123], v[76:79]
    v_mfma_f32_16x16x32_bf16 v[80:83], a[236:239], v[120:123], v[80:83]
    buffer_load_dwordx4 a[176:179], v241, s[36:39], s33 offen offset:2048 sc1
    s_add_u32 s32, s32, 5120
    s_add_u32 s33, s33, 5120
    v_mfma_f32_16x16x32_bf16 v[84:87], a[228:231], v[124:127], v[84:87]
    v_mfma_f32_16x16x32_bf16 v[88:91], a[232:235], v[124:127], v[88:91]
    v_mfma_f32_16x16x32_bf16 v[92:95], a[236:239], v[124:127], v[92:95]
    s_waitcnt lgkmcnt(0)
    s_barrier
    v_xor_b32 v144, 128, v142
    ds_read_b32 v213, v144 offset:512
    v_xor_b32 v144, 256, v142
    ds_read_b32 v214, v144 offset:512
    v_xor_b32 v144, 384, v142
    ds_read_b32 v215, v144 offset:512
    ds_read2_b32 v[174:175], v145 offset0:128 offset1:144
    s_waitcnt lgkmcnt(3)
    v_pk_fma_f32 v[48:49], v[212:213], v[188:189], v[48:49] op_sel:[0,0,0] op_sel_hi:[0,1,1]
    v_pk_fma_f32 v[50:51], v[212:213], v[190:191], v[50:51] op_sel:[0,0,0] op_sel_hi:[0,1,1]
    v_pk_fma_f32 v[52:53], v[212:213], v[192:193], v[52:53] op_sel:[0,0,0] op_sel_hi:[0,1,1]
    buffer_load_dwordx4 a[180:183], v244, s[36:39], s32 offen offset:0 sc1
    v_pk_fma_f32 v[54:55], v[212:213], v[194:195], v[54:55] op_sel:[0,0,0] op_sel_hi:[0,1,1]
    v_pk_fma_f32 v[56:57], v[212:213], v[196:197], v[56:57] op_sel:[0,0,0] op_sel_hi:[0,1,1]
    v_pk_fma_f32 v[58:59], v[212:213], v[198:199], v[58:59] op_sel:[0,0,0] op_sel_hi:[0,1,1]
    v_max_f32 v48, 0, v48
    v_max_f32 v49, 0, v49
    v_max_f32 v52, 0, v52
    v_max_f32 v53, 0, v53
    v_max_f32 v56, 0, v56
    v_max_f32_e64 v57, 0, v57
    v_pk_mul_f32 v[48:49], v[48:49], v[50:51]
    v_pk_mul_f32 v[52:53], v[52:53], v[54:55]
    v_pk_mul_f32 v[56:57], v[56:57], v[58:59]
    buffer_load_dwordx4 a[184:187], v244, s[36:39], s32 offen offset:1024 sc1
    v_cvt_pk_bf16_f32 v48, v48, v49
    v_cvt_pk_bf16_f32 v52, v52, v53
    v_cvt_pk_bf16_f32 v56, v56, v57
    ds_write_b32 v216, v48 offset:45056
    ds_write_b32 v217, v52 offset:45056
    ds_write_b32 v218, v56 offset:45056
    v_pk_fma_f32 v[60:61], v[212:213], v[188:189], v[60:61] op_sel:[1,0,0] op_sel_hi:[1,1,1]
    v_pk_fma_f32 v[62:63], v[212:213], v[190:191], v[62:63] op_sel:[1,0,0] op_sel_hi:[1,1,1]
    v_pk_fma_f32 v[64:65], v[212:213], v[192:193], v[64:65] op_sel:[1,0,0] op_sel_hi:[1,1,1]
    v_pk_fma_f32 v[66:67], v[212:213], v[194:195], v[66:67] op_sel:[1,0,0] op_sel_hi:[1,1,1]
    v_pk_fma_f32 v[68:69], v[212:213], v[196:197], v[68:69] op_sel:[1,0,0] op_sel_hi:[1,1,1]
    v_pk_fma_f32 v[70:71], v[212:213], v[198:199], v[70:71] op_sel:[1,0,0] op_sel_hi:[1,1,1]
    buffer_load_dwordx4 a[188:191], v245, s[36:39], s32 offen offset:0 sc1
    v_max_f32 v60, 0, v60
    v_max_f32 v61, 0, v61
    v_max_f32 v64, 0, v64
    v_max_f32 v65, 0, v65
    v_max_f32 v68, 0, v68
    v_max_f32 v69, 0, v69
    v_pk_mul_f32 v[60:61], v[60:61], v[62:63]
    v_pk_mul_f32 v[64:65], v[64:65], v[66:67]
    v_pk_mul_f32 v[68:69], v[68:69], v[70:71]
    v_cvt_pk_bf16_f32 v60, v60, v61
    v_cvt_pk_bf16_f32 v64, v64, v65
    v_cvt_pk_bf16_f32 v68, v68, v69
    s_waitcnt vmcnt(15)
    buffer_store_dword v243, v242, s[36:39], s26 offen sc1
    ds_write_b32 v219, v60 offset:45056
    ds_write_b32 v220, v64 offset:45056
    ds_write_b32 v221, v68 offset:45056
    s_waitcnt lgkmcnt(7)
    v_pk_fma_f32 v[72:73], v[214:215], v[188:189], v[72:73] op_sel:[0,0,0] op_sel_hi:[0,1,1]
    v_pk_fma_f32 v[74:75], v[214:215], v[190:191], v[74:75] op_sel:[0,0,0] op_sel_hi:[0,1,1]
    v_pk_fma_f32 v[76:77], v[214:215], v[192:193], v[76:77] op_sel:[0,0,0] op_sel_hi:[0,1,1]
    v_pk_fma_f32 v[78:79], v[214:215], v[194:195], v[78:79] op_sel:[0,0,0] op_sel_hi:[0,1,1]
    v_pk_fma_f32 v[80:81], v[214:215], v[196:197], v[80:81] op_sel:[0,0,0] op_sel_hi:[0,1,1]
    v_pk_fma_f32 v[82:83], v[214:215], v[198:199], v[82:83] op_sel:[0,0,0] op_sel_hi:[0,1,1]
    v_max_f32 v72, 0, v72
    v_max_f32 v73, 0, v73
    v_max_f32_e64 v76, 0, v76
    buffer_load_dwordx4 a[192:195], v245, s[36:39], s32 offen offset:1024 sc1
    v_max_f32 v77, 0, v77
    v_max_f32 v80, 0, v80
    v_max_f32_e64 v81, 0, v81
    v_pk_mul_f32 v[72:73], v[72:73], v[74:75]
    v_pk_mul_f32 v[76:77], v[76:77], v[78:79]
    v_pk_mul_f32 v[80:81], v[80:81], v[82:83]
    v_cvt_pk_bf16_f32 v72, v72, v73
    v_cvt_pk_bf16_f32 v76, v76, v77
    v_cvt_pk_bf16_f32 v80, v80, v81
    ds_write_b32 v222, v72 offset:45056
    ds_write_b32 v223, v76 offset:45056
    ds_write_b32 v224, v80 offset:45056
    buffer_load_dwordx4 a[196:199], v241, s[36:39], s33 offen offset:2048 sc1
    s_add_u32 s32, s32, 5120
    s_add_u32 s33, s33, 5120
    v_pk_fma_f32 v[84:85], v[214:215], v[188:189], v[84:85] op_sel:[1,0,0] op_sel_hi:[1,1,1]
    v_pk_fma_f32 v[86:87], v[214:215], v[190:191], v[86:87] op_sel:[1,0,0] op_sel_hi:[1,1,1]
    v_pk_fma_f32 v[88:89], v[214:215], v[192:193], v[88:89] op_sel:[1,0,0] op_sel_hi:[1,1,1]
    v_pk_fma_f32 v[90:91], v[214:215], v[194:195], v[90:91] op_sel:[1,0,0] op_sel_hi:[1,1,1]
    v_pk_fma_f32 v[92:93], v[214:215], v[196:197], v[92:93] op_sel:[1,0,0] op_sel_hi:[1,1,1]
    v_pk_fma_f32 v[94:95], v[214:215], v[198:199], v[94:95] op_sel:[1,0,0] op_sel_hi:[1,1,1]
    v_max_f32 v84, 0, v84
    v_max_f32 v85, 0, v85
    v_max_f32 v88, 0, v88
    v_max_f32 v89, 0, v89
    v_max_f32 v92, 0, v92
    v_max_f32 v93, 0, v93
    buffer_load_dwordx4 a[200:203], v244, s[36:39], s32 offen offset:0 sc1
    v_pk_mul_f32 v[84:85], v[84:85], v[86:87]
    v_pk_mul_f32 v[88:89], v[88:89], v[90:91]
    v_pk_mul_f32 v[92:93], v[92:93], v[94:95]
    v_cvt_pk_bf16_f32 v84, v84, v85
    v_cvt_pk_bf16_f32 v88, v88, v89
    v_cvt_pk_bf16_f32 v92, v92, v93
    ds_write_b32 v225, v84 offset:45056
    ds_write_b32 v226, v88 offset:45056
    ds_write_b32 v227, v92 offset:45056
    s_waitcnt lgkmcnt(0)
    s_barrier
    ds_read2st64_b32 v[148:149], v141 offset0:176 offset1:177
    ds_read2st64_b32 v[150:151], v141 offset0:178 offset1:179
    ds_read2st64_b32 v[152:153], v141 offset0:192 offset1:193
    ds_read2st64_b32 v[154:155], v141 offset0:194 offset1:195
    ds_read2st64_b32 v[156:157], v141 offset0:208 offset1:209
    ds_read2st64_b32 v[158:159], v141 offset0:210 offset1:211
    s_waitcnt lgkmcnt(4)
    buffer_store_dwordx4 v[148:151], v241, s[36:39], s25 offen offset:0 sc1
    s_waitcnt lgkmcnt(2)
    buffer_store_dwordx4 v[152:155], v241, s[36:39], s25 offen offset:1024 sc1
    s_waitcnt lgkmcnt(0)
    s_nop 0
    buffer_store_dwordx4 v[156:159], v241, s[36:39], s25 offen offset:2048 sc1
    buffer_load_dwordx4 a[204:207], v244, s[36:39], s32 offen offset:1024 sc1
    buffer_load_dwordx4 a[208:211], v245, s[36:39], s32 offen offset:0 sc1
    buffer_load_dwordx4 a[212:215], v245, s[36:39], s32 offen offset:1024 sc1
    buffer_load_dwordx4 a[216:219], v241, s[36:39], s33 offen offset:2048 sc1
    s_add_u32 s32, s32, 5120
    s_add_u32 s33, s33, 5120
    buffer_load_dwordx4 a[220:223], v244, s[36:39], s32 offen offset:0 sc1
    buffer_load_dwordx4 a[224:227], v244, s[36:39], s32 offen offset:1024 sc1
    buffer_load_dword v255, v246, s[36:39], s5 offen sc1
    buffer_load_dwordx4 a[228:231], v245, s[36:39], s32 offen offset:0 sc1
    buffer_load_dwordx4 a[232:235], v245, s[36:39], s32 offen offset:1024 sc1
    buffer_load_dwordx4 a[236:239], v241, s[36:39], s33 offen offset:2048 sc1
    s_add_u32 s32, s32, 5120
    s_add_u32 s33, s33, 5120
    s_waitcnt vmcnt(10)
    buffer_store_dword v243, v242, s[36:39], s27 offen sc1
    s_mov_b32 s70, 0
    s_waitcnt vmcnt(4)
    v_cmp_ne_u32 vcc, s56, v255
    s_cbranch_vccz POLLD2
POLL2:
    buffer_load_dword v255, v246, s[36:39], s5 offen sc1
    s_add_u32 s70, s70, 1
    s_cmp_gt_u32 s70, 200000
    s_waitcnt vmcnt(0)
    s_cbranch_scc1 POLLD2
    v_cmp_ne_u32 vcc, s56, v255
    s_cbranch_vccnz POLL2
POLLD2:
    s_add_u32 s75, s4, 0
    buffer_load_dwordx4 v[0:3], v247, s[36:39], s75 offen offset:0 sc1
    s_add_u32 s75, s4, 0
    buffer_load_dwordx4 v[4:7], v248, s[36:39], s75 offen offset:0 sc1
    s_add_u32 s75, s4, 0
    buffer_load_dwordx4 v[8:11], v247, s[36:39], s75 offen offset:1024 sc1
    s_add_u32 s75, s4, 0
    buffer_load_dwordx4 v[12:15], v248, s[36:39], s75 offen offset:1024 sc1
    s_add_u32 s75, s4, 0
    buffer_load_dwordx4 v[16:19], v247, s[36:39], s75 offen offset:2048 sc1
    s_add_u32 s75, s4, 0
    buffer_load_dwordx4 v[20:23], v248, s[36:39], s75 offen offset:2048 sc1
    s_add_u32 s75, s4, 0
    buffer_load_dwordx4 v[24:27], v247, s[36:39], s75 offen offset:3072 sc1
    s_add_u32 s75, s4, 0
    buffer_load_dwordx4 v[28:31], v248, s[36:39], s75 offen offset:3072 sc1
    s_add_u32 s75, s4, 4096
    buffer_load_dwordx4 v[32:35], v247, s[36:39], s75 offen offset:0 sc1
    s_add_u32 s75, s4, 4096
    buffer_load_dwordx4 v[36:39], v248, s[36:39], s75 offen offset:0 sc1
    s_waitcnt vmcnt(9)
    s_nop 0
    v_mfma_f32_16x16x32_bf16 v[188:191], a[0:3], v[0:3], 0
    v_mul_f32 v173, 0x3acccccd, v173
    v_mfma_f32_16x16x32_bf16 v[192:195], a[4:7], v[0:3], 0
    s_add_u32 s75, s4, 4096
    buffer_load_dwordx4 v[40:43], v247, s[36:39], s75 offen offset:1024 sc1
    v_mfma_f32_16x16x32_bf16 v[196:199], a[8:11], v[0:3], 0
    v_fma_f32 v173, -v172, v172, v173
    v_mfma_f32_16x16x32_bf16 v[200:203], a[12:15], v[0:3], 0
    s_add_u32 s75, s4, 4096
    buffer_load_dwordx4 v[44:47], v248, s[36:39], s75 offen offset:1024 sc1
    v_mfma_f32_16x16x32_bf16 v[204:207], a[16:19], v[0:3], 0
    v_max_f32 v173, 0, v173
    s_waitcnt vmcnt(10)
    v_mfma_f32_16x16x32_bf16 v[208:211], a[0:3], v[4:7], 0
    s_add_u32 s75, s4, 4096
    buffer_load_dwordx4 v[48:51], v247, s[36:39], s75 offen offset:2048 sc1
    v_mfma_f32_16x16x32_bf16 v[212:215], a[4:7], v[4:7], 0
    v_cvt_pk_bf16_f32 v159, v173, v173
    v_mfma_f32_16x16x32_bf16 v[216:219], a[8:11], v[4:7], 0
    s_add_u32 s75, s4, 4096
    buffer_load_dwordx4 v[52:55], v248, s[36:39], s75 offen offset:2048 sc1
    v_mfma_f32_16x16x32_bf16 v[220:223], a[12:15], v[4:7], 0
    v_lshlrev_b32_e64 v173, 16, v159
    v_mfma_f32_16x16x32_bf16 v[224:227], a[16:19], v[4:7], 0
    s_add_u32 s75, s4, 4096
    buffer_load_dwordx4 v[56:59], v247, s[36:39], s75 offen offset:3072 sc1
    s_waitcnt vmcnt(12)
    s_nop 0
    v_mfma_f32_16x16x32_bf16 v[188:191], a[20:23], v[8:11], v[188:191]
    v_add_f32 v173, 0x3727c5ac, v173
    v_mfma_f32_16x16x32_bf16 v[192:195], a[24:27], v[8:11], v[192:195]
    s_add_u32 s75, s4, 4096
    buffer_load_dwordx4 v[60:63], v248, s[36:39], s75 offen offset:3072 sc1
    v_mfma_f32_16x16x32_bf16 v[196:199], a[28:31], v[8:11], v[196:199]
    v_cvt_pk_bf16_f32 v159, v173, v173
    v_mfma_f32_16x16x32_bf16 v[200:203], a[32:35], v[8:11], v[200:203]
    s_add_u32 s75, s4, 8192
    buffer_load_dwordx4 v[64:67], v247, s[36:39], s75 offen offset:0 sc1
    v_mfma_f32_16x16x32_bf16 v[204:207], a[36:39], v[8:11], v[204:207]
    v_lshlrev_b32 v173, 16, v159
    s_waitcnt vmcnt(13)
    v_mfma_f32_16x16x32_bf16 v[208:211], a[20:23], v[12:15], v[208:211]
    s_add_u32 s75, s4, 8192
    buffer_load_dwordx4 v[68:71], v248, s[36:39], s75 offen offset:0 sc1
    v_mfma_f32_16x16x32_bf16 v[212:215], a[24:27], v[12:15], v[212:215]
    v_sqrt_f32_e64 v173, v173
    v_mfma_f32_16x16x32_bf16 v[216:219], a[28:31], v[12:15], v[216:219]
    s_add_u32 s75, s4, 8192
    buffer_load_dwordx4 v[72:75], v247, s[36:39], s75 offen offset:1024 sc1
    v_mfma_f32_16x16x32_bf16 v[220:223], a[32:35], v[12:15], v[220:223]
    v_cvt_pk_bf16_f32 v159, v173, v173
    v_mfma_f32_16x16x32_bf16 v[224:227], a[36:39], v[12:15], v[224:227]
    s_add_u32 s75, s4, 8192
    buffer_load_dwordx4 v[76:79], v248, s[36:39], s75 offen offset:1024 sc1
    s_waitcnt vmcnt(15)
    v_mfma_f32_16x16x32_bf16 v[188:191], a[40:43], v[16:19], v[188:191]
    v_lshlrev_b32 v173, 16, v159
    v_mfma_f32_16x16x32_bf16 v[192:195], a[44:47], v[16:19], v[192:195]
    s_add_u32 s75, s4, 8192
    buffer_load_dwordx4 v[80:83], v247, s[36:39], s75 offen offset:2048 sc1
    v_mfma_f32_16x16x32_bf16 v[196:199], a[48:51], v[16:19], v[196:199]
    v_rcp_f32_e64 v173, v173
    v_mfma_f32_16x16x32_bf16 v[200:203], a[52:55], v[16:19], v[200:203]
    s_add_u32 s75, s4, 8192
    buffer_load_dwordx4 v[84:87], v248, s[36:39], s75 offen offset:2048 sc1
    v_mfma_f32_16x16x32_bf16 v[204:207], a[56:59], v[16:19], v[204:207]
    v_mul_f32 v173, v173, v173
    s_waitcnt vmcnt(16)
    v_mfma_f32_16x16x32_bf16 v[208:211], a[40:43], v[20:23], v[208:211]
    s_add_u32 s75, s4, 8192
    buffer_load_dwordx4 v[88:91], v247, s[36:39], s75 offen offset:3072 sc1
    v_mfma_f32_16x16x32_bf16 v[212:215], a[44:47], v[20:23], v[212:215]
    v_lshlrev_b32_e64 v160, 16, v176
    v_mfma_f32_16x16x32_bf16 v[216:219], a[48:51], v[20:23], v[216:219]
    s_add_u32 s75, s4, 8192
    buffer_load_dwordx4 v[92:95], v248, s[36:39], s75 offen offset:3072 sc1
    v_mfma_f32_16x16x32_bf16 v[220:223], a[52:55], v[20:23], v[220:223]
    v_and_b32 v161, 0xffff0000, v176
    v_mfma_f32_16x16x32_bf16 v[224:227], a[56:59], v[20:23], v[224:227]
    v_lshlrev_b32 v162, 16, v177
    s_waitcnt vmcnt(17)
    v_mfma_f32_16x16x32_bf16 v[188:191], a[60:63], v[24:27], v[188:191]
    v_and_b32 v163, 0xffff0000, v177
    v_mfma_f32_16x16x32_bf16 v[192:195], a[64:67], v[24:27], v[192:195]
    v_lshlrev_b32_e64 v164, 16, v178
    v_mfma_f32_16x16x32_bf16 v[196:199], a[68:71], v[24:27], v[196:199]
    v_and_b32 v165, 0xffff0000, v178
    v_mfma_f32_16x16x32_bf16 v[200:203], a[72:75], v[24:27], v[200:203]
    v_lshlrev_b32_e64 v166, 16, v179
    v_mfma_f32_16x16x32_bf16 v[204:207], a[76:79], v[24:27], v[204:207]
    v_and_b32 v167, 0xffff0000, v179
    s_waitcnt vmcnt(16)
    v_mfma_f32_16x16x32_bf16 v[208:211], a[60:63], v[28:31], v[208:211]
    v_lshlrev_b32 v168, 16, v180
    v_mfma_f32_16x16x32_bf16 v[212:215], a[64:67], v[28:31], v[212:215]
    v_and_b32 v169, 0xffff0000, v180
    v_mfma_f32_16x16x32_bf16 v[216:219], a[68:71], v[28:31], v[216:219]
    v_lshlrev_b32_e64 v170, 16, v181
    v_mfma_f32_16x16x32_bf16 v[220:223], a[72:75], v[28:31], v[220:223]
    v_and_b32 v171, 0xffff0000, v181
    v_mfma_f32_16x16x32_bf16 v[224:227], a[76:79], v[28:31], v[224:227]
    v_mul_f32 v175, 0x3acccccd, v175
    s_waitcnt vmcnt(15)
    v_mfma_f32_16x16x32_bf16 v[188:191], a[80:83], v[32:35], v[188:191]
    v_fma_f32 v175, -v174, v174, v175
    v_mfma_f32_16x16x32_bf16 v[192:195], a[84:87], v[32:35], v[192:195]
    v_max_f32 v175, 0, v175
    v_mfma_f32_16x16x32_bf16 v[196:199], a[88:91], v[32:35], v[196:199]
    v_cvt_pk_bf16_f32 v159, v175, v175
    v_mfma_f32_16x16x32_bf16 v[200:203], a[92:95], v[32:35], v[200:203]
    v_lshlrev_b32_e64 v175, 16, v159
    v_mfma_f32_16x16x32_bf16 v[204:207], a[96:99], v[32:35], v[204:207]
    v_add_f32 v175, 0x3727c5ac, v175
    s_waitcnt vmcnt(14)
    v_mfma_f32_16x16x32_bf16 v[208:211], a[80:83], v[36:39], v[208:211]
    v_cvt_pk_bf16_f32 v159, v175, v175
    v_mfma_f32_16x16x32_bf16 v[212:215], a[84:87], v[36:39], v[212:215]
    v_lshlrev_b32 v175, 16, v159
    v_mfma_f32_16x16x32_bf16 v[216:219], a[88:91], v[36:39], v[216:219]
    v_sqrt_f32_e64 v175, v175
    v_mfma_f32_16x16x32_bf16 v[220:223], a[92:95], v[36:39], v[220:223]
    v_cvt_pk_bf16_f32 v159, v175, v175
    v_mfma_f32_16x16x32_bf16 v[224:227], a[96:99], v[36:39], v[224:227]
    v_lshlrev_b32 v175, 16, v159
    s_waitcnt vmcnt(13)
    v_mfma_f32_16x16x32_bf16 v[188:191], a[100:103], v[40:43], v[188:191]
    v_rcp_f32_e64 v175, v175
    v_mfma_f32_16x16x32_bf16 v[192:195], a[104:107], v[40:43], v[192:195]
    v_mul_f32_e64 v175, v175, v175
    v_mfma_f32_16x16x32_bf16 v[196:199], a[108:111], v[40:43], v[196:199]
    v_lshlrev_b32_e64 v136, 16, v182
    v_mfma_f32_16x16x32_bf16 v[200:203], a[112:115], v[40:43], v[200:203]
    v_and_b32 v137, 0xffff0000, v182
    v_mfma_f32_16x16x32_bf16 v[204:207], a[116:119], v[40:43], v[204:207]
    v_lshlrev_b32 v138, 16, v183
    s_waitcnt vmcnt(12)
    v_mfma_f32_16x16x32_bf16 v[208:211], a[100:103], v[44:47], v[208:211]
    v_and_b32 v139, 0xffff0000, v183
    v_mfma_f32_16x16x32_bf16 v[212:215], a[104:107], v[44:47], v[212:215]
    v_lshlrev_b32_e64 v140, 16, v184
    v_mfma_f32_16x16x32_bf16 v[216:219], a[108:111], v[44:47], v[216:219]
    v_and_b32 v141, 0xffff0000, v184
    v_mfma_f32_16x16x32_bf16 v[220:223], a[112:115], v[44:47], v[220:223]
    v_lshlrev_b32_e64 v142, 16, v185
    v_mfma_f32_16x16x32_bf16 v[224:227], a[116:119], v[44:47], v[224:227]
    s_add_u32 s5, s5, 65536
    buffer_load_dword v255, v246, s[36:39], s5 offen sc1
    v_and_b32 v143, 0xffff0000, v185
    s_waitcnt vmcnt(12)
    v_mfma_f32_16x16x32_bf16 v[188:191], a[120:123], v[48:51], v[188:191]
    v_lshlrev_b32 v144, 16, v186
    v_mfma_f32_16x16x32_bf16 v[192:195], a[124:127], v[48:51], v[192:195]
    v_and_b32 v145, 0xffff0000, v186
    v_mfma_f32_16x16x32_bf16 v[196:199], a[128:131], v[48:51], v[196:199]
    v_lshlrev_b32_e64 v146, 16, v187
    v_mfma_f32_16x16x32_bf16 v[200:203], a[132:135], v[48:51], v[200:203]
    v_and_b32 v147, 0xffff0000, v187
    v_mfma_f32_16x16x32_bf16 v[204:207], a[136:139], v[48:51], v[204:207]
    s_waitcnt vmcnt(11)
    v_mfma_f32_16x16x32_bf16 v[208:211], a[120:123], v[52:55], v[208:211]
    v_mfma_f32_16x16x32_bf16 v[212:215], a[124:127], v[52:55], v[212:215]
    v_mfma_f32_16x16x32_bf16 v[216:219], a[128:131], v[52:55], v[216:219]
    v_mfma_f32_16x16x32_bf16 v[220:223], a[132:135], v[52:55], v[220:223]
    v_mfma_f32_16x16x32_bf16 v[224:227], a[136:139], v[52:55], v[224:227]
    s_waitcnt vmcnt(10)
    v_mfma_f32_16x16x32_bf16 v[188:191], a[140:143], v[56:59], v[188:191]
    v_mfma_f32_16x16x32_bf16 v[192:195], a[144:147], v[56:59], v[192:195]
    v_mfma_f32_16x16x32_bf16 v[196:199], a[148:151], v[56:59], v[196:199]
    v_mfma_f32_16x16x32_bf16 v[200:203], a[152:155], v[56:59], v[200:203]
    v_mfma_f32_16x16x32_bf16 v[204:207], a[156:159], v[56:59], v[204:207]
    s_waitcnt vmcnt(9)
    v_mfma_f32_16x16x32_bf16 v[208:211], a[140:143], v[60:63], v[208:211]
    v_mfma_f32_16x16x32_bf16 v[212:215], a[144:147], v[60:63], v[212:215]
    v_mfma_f32_16x16x32_bf16 v[216:219], a[148:151], v[60:63], v[216:219]
    v_mfma_f32_16x16x32_bf16 v[220:223], a[152:155], v[60:63], v[220:223]
    v_mfma_f32_16x16x32_bf16 v[224:227], a[156:159], v[60:63], v[224:227]
    s_waitcnt vmcnt(8)
    v_mfma_f32_16x16x32_bf16 v[188:191], a[160:163], v[64:67], v[188:191]
    v_mfma_f32_16x16x32_bf16 v[192:195], a[164:167], v[64:67], v[192:195]
    v_mfma_f32_16x16x32_bf16 v[196:199], a[168:171], v[64:67], v[196:199]
    v_mfma_f32_16x16x32_bf16 v[200:203], a[172:175], v[64:67], v[200:203]
    v_mfma_f32_16x16x32_bf16 v[204:207], a[176:179], v[64:67], v[204:207]
    s_mov_b32 s70, 0
    s_waitcnt vmcnt(0)
    v_cmp_ne_u32 vcc, s56, v255
    s_cbranch_vccz POLLD3
POLL3:
    buffer_load_dword v255, v246, s[36:39], s5 offen sc1
    s_add_u32 s70, s70, 1
    s_cmp_gt_u32 s70, 200000
    s_waitcnt vmcnt(0)
    s_cbranch_scc1 POLLD3
    v_cmp_ne_u32 vcc, s56, v255
    s_nop 0
    s_cbranch_vccnz POLL3
POLLD3:
    v_mfma_f32_16x16x32_bf16 v[208:211], a[160:163], v[68:71], v[208:211]
    v_mfma_f32_16x16x32_bf16 v[212:215], a[164:167], v[68:71], v[212:215]
    s_add_u32 s75, s4, 196608
    buffer_load_dwordx4 v[0:3], v248, s[36:39], s75 offen offset:0 sc1
    v_mfma_f32_16x16x32_bf16 v[216:219], a[168:171], v[68:71], v[216:219]
    v_mfma_f32_16x16x32_bf16 v[220:223], a[172:175], v[68:71], v[220:223]
    v_mfma_f32_16x16x32_bf16 v[224:227], a[176:179], v[68:71], v[224:227]
    s_add_u32 s75, s4, 196608
    buffer_load_dwordx4 v[4:7], v248, s[36:39], s75 offen offset:1024 sc1
    v_mfma_f32_16x16x32_bf16 v[188:191], a[180:183], v[72:75], v[188:191]
    v_mfma_f32_16x16x32_bf16 v[192:195], a[184:187], v[72:75], v[192:195]
    v_mfma_f32_16x16x32_bf16 v[196:199], a[188:191], v[72:75], v[196:199]
    s_add_u32 s75, s4, 196608
    buffer_load_dwordx4 v[8:11], v248, s[36:39], s75 offen offset:2048 sc1
    v_mfma_f32_16x16x32_bf16 v[200:203], a[192:195], v[72:75], v[200:203]
    v_mfma_f32_16x16x32_bf16 v[204:207], a[196:199], v[72:75], v[204:207]
    v_mfma_f32_16x16x32_bf16 v[208:211], a[180:183], v[76:79], v[208:211]
    s_add_u32 s75, s4, 196608
    buffer_load_dwordx4 v[12:15], v248, s[36:39], s75 offen offset:3072 sc1
    v_mfma_f32_16x16x32_bf16 v[212:215], a[184:187], v[76:79], v[212:215]
    v_mfma_f32_16x16x32_bf16 v[216:219], a[188:191], v[76:79], v[216:219]
    v_mfma_f32_16x16x32_bf16 v[220:223], a[192:195], v[76:79], v[220:223]
    s_add_u32 s75, s4, 200704
    buffer_load_dwordx4 v[16:19], v248, s[36:39], s75 offen offset:0 sc1
    v_mfma_f32_16x16x32_bf16 v[224:227], a[196:199], v[76:79], v[224:227]
    v_mfma_f32_16x16x32_bf16 v[188:191], a[200:203], v[80:83], v[188:191]
    v_mfma_f32_16x16x32_bf16 v[192:195], a[204:207], v[80:83], v[192:195]
    s_add_u32 s75, s4, 200704
    buffer_load_dwordx4 v[20:23], v248, s[36:39], s75 offen offset:1024 sc1
    v_mfma_f32_16x16x32_bf16 v[196:199], a[208:211], v[80:83], v[196:199]
    v_mfma_f32_16x16x32_bf16 v[200:203], a[212:215], v[80:83], v[200:203]
    v_mfma_f32_16x16x32_bf16 v[204:207], a[216:219], v[80:83], v[204:207]
    s_add_u32 s75, s4, 200704
    buffer_load_dwordx4 v[24:27], v248, s[36:39], s75 offen offset:2048 sc1
    v_mfma_f32_16x16x32_bf16 v[208:211], a[200:203], v[84:87], v[208:211]
    v_mfma_f32_16x16x32_bf16 v[212:215], a[204:207], v[84:87], v[212:215]
    v_mfma_f32_16x16x32_bf16 v[216:219], a[208:211], v[84:87], v[216:219]
    s_add_u32 s75, s4, 200704
    buffer_load_dwordx4 v[28:31], v248, s[36:39], s75 offen offset:3072 sc1
    v_mfma_f32_16x16x32_bf16 v[220:223], a[212:215], v[84:87], v[220:223]
    v_mfma_f32_16x16x32_bf16 v[224:227], a[216:219], v[84:87], v[224:227]
    v_mfma_f32_16x16x32_bf16 v[188:191], a[220:223], v[88:91], v[188:191]
    s_add_u32 s75, s4, 204800
    buffer_load_dwordx4 v[32:35], v248, s[36:39], s75 offen offset:0 sc1
    v_mfma_f32_16x16x32_bf16 v[192:195], a[224:227], v[88:91], v[192:195]
    v_mfma_f32_16x16x32_bf16 v[196:199], a[228:231], v[88:91], v[196:199]
    v_mfma_f32_16x16x32_bf16 v[200:203], a[232:235], v[88:91], v[200:203]
    s_add_u32 s75, s4, 204800
    buffer_load_dwordx4 v[36:39], v248, s[36:39], s75 offen offset:1024 sc1
    v_mfma_f32_16x16x32_bf16 v[204:207], a[236:239], v[88:91], v[204:207]
    v_mfma_f32_16x16x32_bf16 v[208:211], a[220:223], v[92:95], v[208:211]
    v_mfma_f32_16x16x32_bf16 v[212:215], a[224:227], v[92:95], v[212:215]
    s_add_u32 s75, s4, 204800
    buffer_load_dwordx4 v[40:43], v248, s[36:39], s75 offen offset:2048 sc1
    v_mfma_f32_16x16x32_bf16 v[216:219], a[228:231], v[92:95], v[216:219]
    v_mfma_f32_16x16x32_bf16 v[220:223], a[232:235], v[92:95], v[220:223]
    v_mfma_f32_16x16x32_bf16 v[224:227], a[236:239], v[92:95], v[224:227]
    s_add_u32 s75, s4, 204800
    buffer_load_dwordx4 v[44:47], v248, s[36:39], s75 offen offset:3072 sc1
    s_waitcnt vmcnt(11)
    v_mfma_f32_16x16x32_bf16 v[116:119], a[0:3], v[0:3], 0
    s_nop 0
    s_nop 0
    v_mfma_f32_16x16x32_bf16 v[120:123], a[4:7], v[0:3], 0
    s_nop 0
    ds_write_b128 v229, v[208:211] offset:0
    v_mfma_f32_16x16x32_bf16 v[124:127], a[8:11], v[0:3], 0
    s_add_u32 s75, s4, 196608
    buffer_load_dwordx4 v[48:51], v247, s[36:39], s75 offen offset:0 sc1
    s_nop 0
    v_mfma_f32_16x16x32_bf16 v[128:131], a[12:15], v[0:3], 0
    ds_write_b128 v229, v[212:215] offset:1024
    s_nop 0
    v_mfma_f32_16x16x32_bf16 v[132:135], a[16:19], v[0:3], 0
    ds_write_b128 v230, v[216:219] offset:0
    s_nop 0
    s_waitcnt vmcnt(11)
    v_mfma_f32_16x16x32_bf16 v[116:119], a[20:23], v[4:7], v[116:119]
    s_add_u32 s75, s4, 196608
    buffer_load_dwordx4 v[52:55], v247, s[36:39], s75 offen offset:1024 sc1
    ds_write_b128 v230, v[220:223] offset:1024
    v_mfma_f32_16x16x32_bf16 v[120:123], a[24:27], v[4:7], v[120:123]
    s_nop 0
    ds_write_b128 v232, v[224:227] offset:0
    v_mfma_f32_16x16x32_bf16 v[124:127], a[28:31], v[4:7], v[124:127]
    s_nop 0
    ds_write_b128 v228, v[196:199] offset:0
    v_mfma_f32_16x16x32_bf16 v[128:131], a[32:35], v[4:7], v[128:131]
    s_add_u32 s75, s4, 196608
    buffer_load_dwordx4 v[56:59], v247, s[36:39], s75 offen offset:2048 sc1
    s_nop 0
    v_mfma_f32_16x16x32_bf16 v[132:135], a[36:39], v[4:7], v[132:135]
    ds_write_b128 v228, v[200:203] offset:1024
    s_nop 0
    s_waitcnt vmcnt(12)
    v_mfma_f32_16x16x32_bf16 v[116:119], a[40:43], v[8:11], v[116:119]
    ds_write_b128 v231, v[204:207] offset:0
    s_nop 0
    v_mfma_f32_16x16x32_bf16 v[120:123], a[44:47], v[8:11], v[120:123]
    s_add_u32 s75, s4, 196608
    buffer_load_dwordx4 v[60:63], v247, s[36:39], s75 offen offset:3072 sc1
    s_nop 0
    v_mfma_f32_16x16x32_bf16 v[124:127], a[48:51], v[8:11], v[124:127]
    s_nop 0
    s_nop 0
    v_mfma_f32_16x16x32_bf16 v[128:131], a[52:55], v[8:11], v[128:131]
    s_waitcnt lgkmcnt(0)
    s_barrier
    ds_read_b128 v[200:203], v233 offset:0
    v_mfma_f32_16x16x32_bf16 v[132:135], a[56:59], v[8:11], v[132:135]
    s_add_u32 s75, s4, 200704
    buffer_load_dwordx4 v[64:67], v247, s[36:39], s75 offen offset:0 sc1
    ds_read_b128 v[204:207], v233 offset:1024
    s_waitcnt vmcnt(13)
    v_mfma_f32_16x16x32_bf16 v[116:119], a[60:63], v[12:15], v[116:119]
    ds_read_b128 v[208:211], v233 offset:2048
    ds_read_b128 v[212:215], v233 offset:3072
    v_mfma_f32_16x16x32_bf16 v[120:123], a[64:67], v[12:15], v[120:123]
    ds_read_b128 v[216:219], v233 offset:4096
    ds_read_b128 v[220:223], v233 offset:5120
    v_mfma_f32_16x16x32_bf16 v[124:127], a[68:71], v[12:15], v[124:127]
    s_add_u32 s75, s4, 200704
    buffer_load_dwordx4 v[68:71], v247, s[36:39], s75 offen offset:1024 sc1
    ds_read_b128 v[196:199], v234 offset:0
    v_mfma_f32_16x16x32_bf16 v[128:131], a[72:75], v[12:15], v[128:131]
    ds_read_b128 v[224:227], v234 offset:1024
    ds_read_b128 v[148:151], v234 offset:2048
    v_mfma_f32_16x16x32_bf16 v[132:135], a[76:79], v[12:15], v[132:135]
    ds_read_b128 v[152:155], v234 offset:3072
    s_nop 0
    s_waitcnt vmcnt(13)
    v_mfma_f32_16x16x32_bf16 v[116:119], a[80:83], v[16:19], v[116:119]
    s_add_u32 s75, s4, 200704
    buffer_load_dwordx4 v[72:75], v247, s[36:39], s75 offen offset:2048 sc1
    s_nop 0
    v_mfma_f32_16x16x32_bf16 v[120:123], a[84:87], v[16:19], v[120:123]
    s_nop 0
    s_nop 0
    v_mfma_f32_16x16x32_bf16 v[124:127], a[88:91], v[16:19], v[124:127]
    s_waitcnt lgkmcnt(9)
    v_add_f32 v188, v188, v200
    v_add_f32 v189, v189, v201
    v_mfma_f32_16x16x32_bf16 v[128:131], a[92:95], v[16:19], v[128:131]
    s_add_u32 s75, s4, 200704
    buffer_load_dwordx4 v[76:79], v247, s[36:39], s75 offen offset:3072 sc1
    v_add_f32_e64 v190, v190, v202
    v_mfma_f32_16x16x32_bf16 v[132:135], a[96:99], v[16:19], v[132:135]
    v_add_f32 v191, v191, v203
    s_waitcnt lgkmcnt(8)
    v_add_f32 v192, v192, v204
    s_waitcnt vmcnt(14)
    v_mfma_f32_16x16x32_bf16 v[116:119], a[100:103], v[20:23], v[116:119]
    v_add_f32 v193, v193, v205
    v_add_f32 v194, v194, v206
    v_mfma_f32_16x16x32_bf16 v[120:123], a[104:107], v[20:23], v[120:123]
    s_add_u32 s75, s4, 204800
    buffer_load_dwordx4 v[80:83], v247, s[36:39], s75 offen offset:0 sc1
    v_add_f32_e64 v195, v195, v207
    v_mfma_f32_16x16x32_bf16 v[124:127], a[108:111], v[20:23], v[124:127]
    s_waitcnt lgkmcnt(7)
    v_add_f32 v188, v188, v208
    v_add_f32_e64 v189, v189, v209
    v_mfma_f32_16x16x32_bf16 v[128:131], a[112:115], v[20:23], v[128:131]
    v_add_f32 v190, v190, v210
    v_add_f32 v191, v191, v211
    v_mfma_f32_16x16x32_bf16 v[132:135], a[116:119], v[20:23], v[132:135]
    s_add_u32 s75, s4, 204800
    buffer_load_dwordx4 v[84:87], v247, s[36:39], s75 offen offset:1024 sc1
    s_waitcnt lgkmcnt(6)
    v_add_f32 v192, v192, v212
    s_waitcnt vmcnt(15)
    v_mfma_f32_16x16x32_bf16 v[116:119], a[120:123], v[24:27], v[116:119]
    v_add_f32 v193, v193, v213
    v_add_f32_e64 v194, v194, v214
    v_mfma_f32_16x16x32_bf16 v[120:123], a[124:127], v[24:27], v[120:123]
    v_add_f32 v195, v195, v215
    s_waitcnt lgkmcnt(5)
    v_add_f32_e64 v188, v188, v216
    v_mfma_f32_16x16x32_bf16 v[124:127], a[128:131], v[24:27], v[124:127]
    s_add_u32 s75, s4, 204800
    buffer_load_dwordx4 v[88:91], v247, s[36:39], s75 offen offset:2048 sc1
    v_add_f32_e64 v189, v189, v217
    v_mfma_f32_16x16x32_bf16 v[128:131], a[132:135], v[24:27], v[128:131]
    v_add_f32 v190, v190, v218
    v_add_f32 v191, v191, v219
    v_mfma_f32_16x16x32_bf16 v[132:135], a[136:139], v[24:27], v[132:135]
    s_waitcnt lgkmcnt(4)
    v_add_f32 v192, v192, v220
    v_add_f32 v193, v193, v221
    s_waitcnt vmcnt(15)
    v_mfma_f32_16x16x32_bf16 v[116:119], a[140:143], v[28:31], v[116:119]
    s_add_u32 s75, s4, 204800
    buffer_load_dwordx4 v[92:95], v247, s[36:39], s75 offen offset:3072 sc1
    v_add_f32_e64 v194, v194, v222
    v_mfma_f32_16x16x32_bf16 v[120:123], a[144:147], v[28:31], v[120:123]
    v_add_f32 v195, v195, v223
    s_waitcnt lgkmcnt(2)
    v_add_f32_e64 v196, v196, v224
    v_mfma_f32_16x16x32_bf16 v[124:127], a[148:151], v[28:31], v[124:127]
    v_add_f32 v197, v197, v225
    v_add_f32 v198, v198, v226
    v_mfma_f32_16x16x32_bf16 v[128:131], a[152:155], v[28:31], v[128:131]
    v_add_f32 v199, v199, v227
    s_waitcnt lgkmcnt(1)
    v_add_f32_e64 v196, v196, v148
    v_mfma_f32_16x16x32_bf16 v[132:135], a[156:159], v[28:31], v[132:135]
    v_add_f32 v197, v197, v149
    v_add_f32 v198, v198, v150
    s_waitcnt vmcnt(15)
    v_mfma_f32_16x16x32_bf16 v[116:119], a[160:163], v[32:35], v[116:119]
    v_add_f32 v199, v199, v151
    s_waitcnt lgkmcnt(0)
    v_add_f32 v196, v196, v152
    v_mfma_f32_16x16x32_bf16 v[120:123], a[164:167], v[32:35], v[120:123]
    v_add_f32 v197, v197, v153
    v_add_f32 v198, v198, v154
    v_mfma_f32_16x16x32_bf16 v[124:127], a[168:171], v[32:35], v[124:127]
    v_add_f32_e64 v199, v199, v155
    v_fma_f32 v188, v188, v173, v160
    v_mfma_f32_16x16x32_bf16 v[128:131], a[172:175], v[32:35], v[128:131]
    v_fma_f32 v189, v189, v173, v161
    v_fma_f32 v190, v190, v173, v162
    v_mfma_f32_16x16x32_bf16 v[132:135], a[176:179], v[32:35], v[132:135]
    v_fma_f32 v191, v191, v173, v163
    v_fma_f32 v192, v192, v173, v164
    s_waitcnt vmcnt(14)
    s_nop 0
    v_mfma_f32_16x16x32_bf16 v[116:119], a[180:183], v[36:39], v[116:119]
    v_fma_f32 v193, v193, v173, v165
    v_fma_f32 v194, v194, v173, v166
    v_mfma_f32_16x16x32_bf16 v[120:123], a[184:187], v[36:39], v[120:123]
    v_fma_f32 v195, v195, v173, v167
    v_fma_f32 v196, v196, v173, v168
    v_mfma_f32_16x16x32_bf16 v[124:127], a[188:191], v[36:39], v[124:127]
    v_fma_f32 v197, v197, v173, v169
    v_fma_f32 v198, v198, v173, v170
    v_mfma_f32_16x16x32_bf16 v[128:131], a[192:195], v[36:39], v[128:131]
    v_fma_f32 v199, v199, v173, v171
    v_cvt_pk_bf16_f32 v204, v188, v189
    v_mfma_f32_16x16x32_bf16 v[132:135], a[196:199], v[36:39], v[132:135]
    v_cvt_pk_bf16_f32 v205, v190, v191
    v_cvt_pk_bf16_f32 v206, v192, v193
    s_waitcnt vmcnt(13)
    s_nop 0
    v_mfma_f32_16x16x32_bf16 v[116:119], a[200:203], v[40:43], v[116:119]
    v_cvt_pk_bf16_f32 v207, v194, v195
    v_cvt_pk_bf16_f32 v208, v196, v197
    v_mfma_f32_16x16x32_bf16 v[120:123], a[204:207], v[40:43], v[120:123]
    v_cvt_pk_bf16_f32 v209, v198, v199
    buffer_store_dwordx4 v[204:207], v249, s[52:55], s6 offen
    v_mfma_f32_16x16x32_bf16 v[124:127], a[208:211], v[40:43], v[124:127]
    buffer_store_dwordx2 v[208:209], v250, s[52:55], s6 offen
    s_add_u32 s6, s6, 81920
    v_mfma_f32_16x16x32_bf16 v[128:131], a[212:215], v[40:43], v[128:131]
    v_mfma_f32_16x16x32_bf16 v[132:135], a[216:219], v[40:43], v[132:135]
    s_waitcnt vmcnt(14)
    v_mfma_f32_16x16x32_bf16 v[116:119], a[220:223], v[44:47], v[116:119]
    v_mfma_f32_16x16x32_bf16 v[120:123], a[224:227], v[44:47], v[120:123]
    v_mfma_f32_16x16x32_bf16 v[124:127], a[228:231], v[44:47], v[124:127]
    v_mfma_f32_16x16x32_bf16 v[128:131], a[232:235], v[44:47], v[128:131]
    v_mfma_f32_16x16x32_bf16 v[132:135], a[236:239], v[44:47], v[132:135]
    s_waitcnt vmcnt(13)
    v_mfma_f32_16x16x32_bf16 v[96:99], a[0:3], v[48:51], 0
    v_mfma_f32_16x16x32_bf16 v[100:103], a[4:7], v[48:51], 0
    v_mfma_f32_16x16x32_bf16 v[104:107], a[8:11], v[48:51], 0
    v_mfma_f32_16x16x32_bf16 v[108:111], a[12:15], v[48:51], 0
    v_mfma_f32_16x16x32_bf16 v[112:115], a[16:19], v[48:51], 0
    s_waitcnt vmcnt(12)
    v_mfma_f32_16x16x32_bf16 v[96:99], a[20:23], v[52:55], v[96:99]
    v_mfma_f32_16x16x32_bf16 v[100:103], a[24:27], v[52:55], v[100:103]
    v_mfma_f32_16x16x32_bf16 v[104:107], a[28:31], v[52:55], v[104:107]
    v_mfma_f32_16x16x32_bf16 v[108:111], a[32:35], v[52:55], v[108:111]
    v_mfma_f32_16x16x32_bf16 v[112:115], a[36:39], v[52:55], v[112:115]
    s_waitcnt vmcnt(11)
    v_mfma_f32_16x16x32_bf16 v[96:99], a[40:43], v[56:59], v[96:99]
    v_mfma_f32_16x16x32_bf16 v[100:103], a[44:47], v[56:59], v[100:103]
    ds_write_b128 v229, v[116:119] offset:32768
    v_mfma_f32_16x16x32_bf16 v[104:107], a[48:51], v[56:59], v[104:107]
    v_mfma_f32_16x16x32_bf16 v[108:111], a[52:55], v[56:59], v[108:111]
    v_mfma_f32_16x16x32_bf16 v[112:115], a[56:59], v[56:59], v[112:115]
    s_waitcnt vmcnt(10)
    v_mfma_f32_16x16x32_bf16 v[96:99], a[60:63], v[60:63], v[96:99]
    v_mfma_f32_16x16x32_bf16 v[100:103], a[64:67], v[60:63], v[100:103]
    v_mfma_f32_16x16x32_bf16 v[104:107], a[68:71], v[60:63], v[104:107]
    ds_write_b128 v229, v[120:123] offset:33792
    v_mfma_f32_16x16x32_bf16 v[108:111], a[72:75], v[60:63], v[108:111]
    v_mfma_f32_16x16x32_bf16 v[112:115], a[76:79], v[60:63], v[112:115]
    s_waitcnt vmcnt(9)
    v_mfma_f32_16x16x32_bf16 v[96:99], a[80:83], v[64:67], v[96:99]
    v_mfma_f32_16x16x32_bf16 v[100:103], a[84:87], v[64:67], v[100:103]
    v_mfma_f32_16x16x32_bf16 v[104:107], a[88:91], v[64:67], v[104:107]
    v_mfma_f32_16x16x32_bf16 v[108:111], a[92:95], v[64:67], v[108:111]
    ds_write_b128 v230, v[124:127] offset:32768
    v_mfma_f32_16x16x32_bf16 v[112:115], a[96:99], v[64:67], v[112:115]
    s_waitcnt vmcnt(8)
    v_mfma_f32_16x16x32_bf16 v[96:99], a[100:103], v[68:71], v[96:99]
    v_mfma_f32_16x16x32_bf16 v[100:103], a[104:107], v[68:71], v[100:103]
    v_mfma_f32_16x16x32_bf16 v[104:107], a[108:111], v[68:71], v[104:107]
    v_mfma_f32_16x16x32_bf16 v[108:111], a[112:115], v[68:71], v[108:111]
    v_mfma_f32_16x16x32_bf16 v[112:115], a[116:119], v[68:71], v[112:115]
    ds_write_b128 v230, v[128:131] offset:33792
    s_waitcnt vmcnt(7)
    v_mfma_f32_16x16x32_bf16 v[96:99], a[120:123], v[72:75], v[96:99]
    v_mfma_f32_16x16x32_bf16 v[100:103], a[124:127], v[72:75], v[100:103]
    v_mfma_f32_16x16x32_bf16 v[104:107], a[128:131], v[72:75], v[104:107]
    v_mfma_f32_16x16x32_bf16 v[108:111], a[132:135], v[72:75], v[108:111]
    v_mfma_f32_16x16x32_bf16 v[112:115], a[136:139], v[72:75], v[112:115]
    s_waitcnt vmcnt(6)
    v_mfma_f32_16x16x32_bf16 v[96:99], a[140:143], v[76:79], v[96:99]
    ds_write_b128 v232, v[132:135] offset:32768
    v_mfma_f32_16x16x32_bf16 v[100:103], a[144:147], v[76:79], v[100:103]
    v_mfma_f32_16x16x32_bf16 v[104:107], a[148:151], v[76:79], v[104:107]
    v_mfma_f32_16x16x32_bf16 v[108:111], a[152:155], v[76:79], v[108:111]
    v_mfma_f32_16x16x32_bf16 v[112:115], a[156:159], v[76:79], v[112:115]
    s_waitcnt vmcnt(5)
    v_mfma_f32_16x16x32_bf16 v[96:99], a[160:163], v[80:83], v[96:99]
    v_mfma_f32_16x16x32_bf16 v[100:103], a[164:167], v[80:83], v[100:103]
    v_mfma_f32_16x16x32_bf16 v[104:107], a[168:171], v[80:83], v[104:107]
    v_mfma_f32_16x16x32_bf16 v[108:111], a[172:175], v[80:83], v[108:111]
    v_mfma_f32_16x16x32_bf16 v[112:115], a[176:179], v[80:83], v[112:115]
    s_waitcnt vmcnt(4)
    v_mfma_f32_16x16x32_bf16 v[96:99], a[180:183], v[84:87], v[96:99]
    v_mfma_f32_16x16x32_bf16 v[100:103], a[184:187], v[84:87], v[100:103]
    v_mfma_f32_16x16x32_bf16 v[104:107], a[188:191], v[84:87], v[104:107]
    v_mfma_f32_16x16x32_bf16 v[108:111], a[192:195], v[84:87], v[108:111]
    v_mfma_f32_16x16x32_bf16 v[112:115], a[196:199], v[84:87], v[112:115]
    s_waitcnt vmcnt(3)
    v_mfma_f32_16x16x32_bf16 v[96:99], a[200:203], v[88:91], v[96:99]
    v_mfma_f32_16x16x32_bf16 v[100:103], a[204:207], v[88:91], v[100:103]
    v_mfma_f32_16x16x32_bf16 v[104:107], a[208:211], v[88:91], v[104:107]
    v_mfma_f32_16x16x32_bf16 v[108:111], a[212:215], v[88:91], v[108:111]
    v_mfma_f32_16x16x32_bf16 v[112:115], a[216:219], v[88:91], v[112:115]
    s_waitcnt vmcnt(2)
    v_mfma_f32_16x16x32_bf16 v[96:99], a[220:223], v[92:95], v[96:99]
    v_mfma_f32_16x16x32_bf16 v[100:103], a[224:227], v[92:95], v[100:103]
    v_mfma_f32_16x16x32_bf16 v[104:107], a[228:231], v[92:95], v[104:107]
    v_mfma_f32_16x16x32_bf16 v[108:111], a[232:235], v[92:95], v[108:111]
    v_mfma_f32_16x16x32_bf16 v[112:115], a[236:239], v[92:95], v[112:115]
    s_nop 5
    ds_write_b128 v228, v[104:107] offset:32768
    ds_write_b128 v228, v[108:111] offset:33792
    ds_write_b128 v231, v[112:115] offset:32768
    s_waitcnt lgkmcnt(0)
    s_barrier
    ds_read_b128 v[108:111], v233 offset:32768
    ds_read_b128 v[112:115], v233 offset:33792
    ds_read_b128 v[116:119], v233 offset:34816
    ds_read_b128 v[120:123], v233 offset:35840
    ds_read_b128 v[124:127], v233 offset:36864
    ds_read_b128 v[128:131], v233 offset:37888
    ds_read_b128 v[104:107], v234 offset:32768
    ds_read_b128 v[132:135], v234 offset:33792
    ds_read_b128 v[148:151], v234 offset:34816
    ds_read_b128 v[152:155], v234 offset:35840
    s_waitcnt lgkmcnt(9)
    v_pk_add_f32 v[96:97], v[96:97], v[108:109]
    v_pk_add_f32 v[98:99], v[98:99], v[110:111]
    s_waitcnt lgkmcnt(8)
    v_pk_add_f32 v[100:101], v[100:101], v[112:113]
    v_pk_add_f32 v[102:103], v[102:103], v[114:115]
    s_waitcnt lgkmcnt(7)
    v_pk_add_f32 v[96:97], v[96:97], v[116:117]
    v_pk_add_f32 v[98:99], v[98:99], v[118:119]
    s_waitcnt lgkmcnt(6)
    v_pk_add_f32 v[100:101], v[100:101], v[120:121]
    v_pk_add_f32 v[102:103], v[102:103], v[122:123]
    s_waitcnt lgkmcnt(5)
    v_pk_add_f32 v[96:97], v[96:97], v[124:125]
    v_pk_add_f32 v[98:99], v[98:99], v[126:127]
    s_waitcnt lgkmcnt(4)
    v_pk_add_f32 v[100:101], v[100:101], v[128:129]
    v_pk_add_f32 v[102:103], v[102:103], v[130:131]
    s_waitcnt lgkmcnt(2)
    v_pk_add_f32 v[104:105], v[104:105], v[132:133]
    v_pk_add_f32 v[106:107], v[106:107], v[134:135]
    s_waitcnt lgkmcnt(1)
    v_pk_add_f32 v[104:105], v[104:105], v[148:149]
    v_pk_add_f32 v[106:107], v[106:107], v[150:151]
    s_waitcnt lgkmcnt(0)
    s_nop 0
    v_pk_add_f32 v[104:105], v[104:105], v[152:153]
    v_pk_add_f32 v[106:107], v[106:107], v[154:155]
    v_pk_fma_f32 v[96:97], v[96:97], v[174:175], v[136:137] op_sel:[0,1,0] op_sel_hi:[1,1,1]
    v_pk_fma_f32 v[98:99], v[98:99], v[174:175], v[138:139] op_sel:[0,1,0] op_sel_hi:[1,1,1]
    v_pk_fma_f32 v[100:101], v[100:101], v[174:175], v[140:141] op_sel:[0,1,0] op_sel_hi:[1,1,1]
    v_pk_fma_f32 v[102:103], v[102:103], v[174:175], v[142:143] op_sel:[0,1,0] op_sel_hi:[1,1,1]
    v_pk_fma_f32 v[104:105], v[104:105], v[174:175], v[144:145] op_sel:[0,1,0] op_sel_hi:[1,1,1]
    v_pk_fma_f32 v[106:107], v[106:107], v[174:175], v[146:147] op_sel:[0,1,0] op_sel_hi:[1,1,1]
    v_cvt_pk_bf16_f32 v112, v96, v97
    v_cvt_pk_bf16_f32 v113, v98, v99
    v_cvt_pk_bf16_f32 v114, v100, v101
    v_cvt_pk_bf16_f32 v115, v102, v103
    v_cvt_pk_bf16_f32 v116, v104, v105
    v_cvt_pk_bf16_f32 v117, v106, v107
    buffer_store_dwordx4 v[112:115], v249, s[52:55], s6 offen
    buffer_store_dwordx2 v[116:117], v250, s[52:55], s6 offen
    s_cmp_eq_u32 s2, 0
    s_cbranch_scc0 NOGEN
    s_cmp_eq_u32 s3, 0
    s_cbranch_scc0 NOGEN
    buffer_store_dword v243, v242, s[36:39], 0 offen sc1
NOGEN:
END:
    s_endpgm
RTY0:
    s_mov_b32 s70, 0
RTL0:
    s_sleep 2
    s_add_u32 m0, s19, 0
    s_add_u32 s75, s18, 0
    s_nop 0
    buffer_load_dwordx4 v128, s[36:39], s75 offen sc1 lds
    s_add_u32 m0, s19, 4096
    s_add_u32 s75, s18, 655360
    buffer_load_dwordx4 v128, s[36:39], s75 offen sc1 lds
    s_add_u32 m0, s19, 8192
    s_add_u32 s75, s18, 1310720
    buffer_load_dwordx4 v128, s[36:39], s75 offen sc1 lds
    s_add_u32 m0, s19, 12288
    s_add_u32 s75, s18, 1966080
    buffer_load_dwordx4 v128, s[36:39], s75 offen sc1 lds
    s_waitcnt vmcnt(0)
    ds_read_b32 v170, v131 offset:0
    ds_read_b32 v171, v131 offset:4096
    ds_read_b32 v254, v131 offset:8192
    ds_read_b32 v251, v131 offset:12288
    s_waitcnt lgkmcnt(0)
    v_max3_u32 v170, v170, v171, v254
    v_max_u32 v170, v170, v251
    s_add_u32 s70, s70, 1
    s_cmp_gt_u32 s70, 200000
    s_cbranch_scc1 CNT0
    v_cmp_eq_u32 vcc, -1, v170
    s_cbranch_vccnz RTL0
    s_branch CNT0
RTY1:
    s_mov_b32 s70, 0
RTL1:
    s_sleep 2
    s_add_u32 m0, s19, 16384
    s_add_u32 s75, s18, 128
    buffer_load_dwordx4 v128, s[36:39], s75 offen sc1 lds
    s_add_u32 m0, s19, 20480
    s_add_u32 s75, s18, 655488
    buffer_load_dwordx4 v128, s[36:39], s75 offen sc1 lds
    s_add_u32 m0, s19, 24576
    s_add_u32 s75, s18, 1310848
    buffer_load_dwordx4 v128, s[36:39], s75 offen sc1 lds
    s_add_u32 m0, s19, 28672
    s_add_u32 s75, s18, 1966208
    buffer_load_dwordx4 v128, s[36:39], s75 offen sc1 lds
    s_waitcnt vmcnt(0)
    ds_read_b32 v170, v131 offset:16384
    ds_read_b32 v171, v131 offset:20480
    ds_read_b32 v254, v131 offset:24576
    ds_read_b32 v251, v131 offset:28672
    s_waitcnt lgkmcnt(0)
    v_max3_u32 v170, v170, v171, v254
    v_max_u32 v170, v170, v251
    s_add_u32 s70, s70, 1
    s_cmp_gt_u32 s70, 200000
    s_cbranch_scc1 CNT1
    v_cmp_eq_u32 vcc, -1, v170
    s_cbranch_vccnz RTL1
    s_branch CNT1
RTY2:
    s_mov_b32 s70, 0
RTL2:
    s_sleep 2
    s_add_u32 m0, s19, 32768
    s_add_u32 s75, s18, 0
    s_nop 0
    buffer_load_dwordx4 v129, s[36:39], s75 offen sc1 lds
    s_add_u32 m0, s19, 36864
    s_add_u32 s75, s18, 327680
    buffer_load_dwordx4 v129, s[36:39], s75 offen sc1 lds
    s_add_u32 m0, s19, 40960
    s_add_u32 s75, s18, 655360
    buffer_load_dwordx4 v129, s[36:39], s75 offen sc1 lds
    s_add_u32 m0, s19, 45056
    s_add_u32 s75, s18, 983040
    buffer_load_dwordx4 v129, s[36:39], s75 offen sc1 lds
    s_waitcnt vmcnt(0)
    ds_read_b32 v170, v131 offset:32768
    ds_read_b32 v171, v131 offset:36864
    ds_read_b32 v254, v131 offset:40960
    ds_read_b32 v251, v131 offset:45056
    s_waitcnt lgkmcnt(0)
    v_max3_u32 v170, v170, v171, v254
    v_max_u32 v170, v170, v251
    s_add_u32 s70, s70, 1
    s_cmp_gt_u32 s70, 200000
    s_cbranch_scc1 CNT2
    v_cmp_eq_u32 vcc, -1, v170
    s_cbranch_vccnz RTL2
    s_branch CNT2
RTY3:
    s_mov_b32 s70, 0
RTL3:
    s_sleep 2
    s_add_u32 m0, s19, 49152
    s_add_u32 s75, s18, 1310720
    buffer_load_dwordx4 v129, s[36:39], s75 offen sc1 lds
    s_add_u32 m0, s19, 53248
    s_add_u32 s75, s18, 1638400
    buffer_load_dwordx4 v129, s[36:39], s75 offen sc1 lds
    s_add_u32 m0, s19, 57344
    s_add_u32 s75, s18, 1966080
    buffer_load_dwordx4 v129, s[36:39], s75 offen sc1 lds
    s_add_u32 m0, s19, 61440
    s_add_u32 s75, s18, 2293760
    buffer_load_dwordx4 v129, s[36:39], s75 offen sc1 lds
    s_waitcnt vmcnt(0)
    ds_read_b32 v170, v131 offset:49152
    ds_read_b32 v171, v131 offset:53248
    ds_read_b32 v254, v131 offset:57344
    ds_read_b32 v251, v131 offset:61440
    s_waitcnt lgkmcnt(0)
    v_max3_u32 v170, v170, v171, v254
    v_max_u32 v170, v170, v251
    s_add_u32 s70, s70, 1
    s_cmp_gt_u32 s70, 200000
    s_cbranch_scc1 CNT3
    v_cmp_eq_u32 vcc, -1, v170
    s_cbranch_vccnz RTL3
    s_branch CNT3
RTY4:
    s_mov_b32 s70, 0
RTL4:
    s_sleep 2
    s_add_u32 m0, s19, 65536
    s_add_u32 s75, s18, 4096
    buffer_load_dwordx4 v129, s[36:39], s75 offen sc1 lds
    s_add_u32 m0, s19, 69632
    s_add_u32 s75, s18, 128
    buffer_load_dwordx4 v129, s[36:39], s75 offen sc1 lds
    s_add_u32 m0, s19, 73728
    s_add_u32 s75, s18, 331776
    buffer_load_dwordx4 v129, s[36:39], s75 offen sc1 lds
    s_add_u32 m0, s19, 77824
    s_add_u32 s75, s18, 327808
    buffer_load_dwordx4 v129, s[36:39], s75 offen sc1 lds
    s_waitcnt vmcnt(0)
    ds_read_b32 v170, v252 offset:0
    ds_read_b32 v171, v252 offset:4096
    ds_read_b32 v254, v252 offset:8192
    ds_read_b32 v251, v252 offset:12288
    s_waitcnt lgkmcnt(0)
    v_max3_u32 v170, v170, v171, v254
    v_max_u32 v170, v170, v251
    s_add_u32 s70, s70, 1
    s_cmp_gt_u32 s70, 200000
    s_cbranch_scc1 CNT4
    v_cmp_eq_u32 vcc, -1, v170
    s_cbranch_vccnz RTL4
    s_branch CNT4
RTY5:
    s_mov_b32 s70, 0
RTL5:
    s_sleep 2
    s_add_u32 m0, s19, 81920
    s_add_u32 s75, s18, 659456
    buffer_load_dwordx4 v129, s[36:39], s75 offen sc1 lds
    s_add_u32 m0, s19, 86016
    s_add_u32 s75, s18, 655488
    buffer_load_dwordx4 v129, s[36:39], s75 offen sc1 lds
    s_add_u32 m0, s19, 90112
    s_add_u32 s75, s18, 987136
    buffer_load_dwordx4 v129, s[36:39], s75 offen sc1 lds
    s_add_u32 m0, s19, 94208
    s_add_u32 s75, s18, 983168
    buffer_load_dwordx4 v129, s[36:39], s75 offen sc1 lds
    s_waitcnt vmcnt(0)
    ds_read_b32 v170, v252 offset:16384
    ds_read_b32 v171, v252 offset:20480
    ds_read_b32 v254, v252 offset:24576
    ds_read_b32 v251, v252 offset:28672
    s_waitcnt lgkmcnt(0)
    v_max3_u32 v170, v170, v171, v254
    v_max_u32 v170, v170, v251
    s_add_u32 s70, s70, 1
    s_cmp_gt_u32 s70, 200000
    s_cbranch_scc1 CNT5
    v_cmp_eq_u32 vcc, -1, v170
    s_cbranch_vccnz RTL5
    s_branch CNT5
RTY6:
    s_mov_b32 s70, 0
RTL6:
    s_sleep 2
    s_add_u32 m0, s19, 98304
    s_add_u32 s75, s18, 1314816
    buffer_load_dwordx4 v129, s[36:39], s75 offen sc1 lds
    s_add_u32 m0, s19, 102400
    s_add_u32 s75, s18, 1310848
    buffer_load_dwordx4 v129, s[36:39], s75 offen sc1 lds
    s_add_u32 m0, s19, 106496
    s_add_u32 s75, s18, 1642496
    buffer_load_dwordx4 v129, s[36:39], s75 offen sc1 lds
    s_add_u32 m0, s19, 110592
    s_add_u32 s75, s18, 1638528
    buffer_load_dwordx4 v129, s[36:39], s75 offen sc1 lds
    s_waitcnt vmcnt(0)
    ds_read_b32 v170, v252 offset:32768
    ds_read_b32 v171, v252 offset:36864
    ds_read_b32 v254, v252 offset:40960
    ds_read_b32 v251, v252 offset:45056
    s_waitcnt lgkmcnt(0)
    v_max3_u32 v170, v170, v171, v254
    v_max_u32 v170, v170, v251
    s_add_u32 s70, s70, 1
    s_cmp_gt_u32 s70, 200000
    s_cbranch_scc1 CNT6
    v_cmp_eq_u32 vcc, -1, v170
    s_cbranch_vccnz RTL6
    s_branch CNT6
RTY7:
    s_mov_b32 s70, 0
RTL7:
    s_sleep 2
    s_add_u32 m0, s19, 114688
    s_add_u32 s75, s18, 1970176
    buffer_load_dwordx4 v129, s[36:39], s75 offen sc1 lds
    s_add_u32 m0, s19, 118784
    s_add_u32 s75, s18, 1966208
    buffer_load_dwordx4 v129, s[36:39], s75 offen sc1 lds
    s_add_u32 m0, s19, 122880
    s_add_u32 s75, s18, 2297856
    buffer_load_dwordx4 v129, s[36:39], s75 offen sc1 lds
    s_add_u32 m0, s19, 126976
    s_add_u32 s75, s18, 2293888
    buffer_load_dwordx4 v129, s[36:39], s75 offen sc1 lds
    s_waitcnt vmcnt(0)
    ds_read_b32 v170, v252 offset:49152
    ds_read_b32 v171, v252 offset:53248
    ds_read_b32 v254, v252 offset:57344
    ds_read_b32 v251, v252 offset:61440
    s_waitcnt lgkmcnt(0)
    v_max3_u32 v170, v170, v171, v254
    v_max_u32 v170, v170, v251
    s_add_u32 s70, s70, 1
    s_cmp_gt_u32 s70, 200000
    s_cbranch_scc1 CNT7
    v_cmp_eq_u32 vcc, -1, v170
    s_cbranch_vccnz RTL7
    s_branch CNT7
RTY8:
    s_mov_b32 s70, 0
RTL8:
    s_sleep 2
    s_add_u32 m0, s19, 131072
    s_add_u32 s75, s18, 4224
    buffer_load_dwordx4 v129, s[36:39], s75 offen sc1 lds
    s_add_u32 m0, s19, 135168
    s_add_u32 s75, s18, 331904
    buffer_load_dwordx4 v129, s[36:39], s75 offen sc1 lds
    s_add_u32 m0, s19, 139264
    s_add_u32 s75, s18, 659584
    buffer_load_dwordx4 v129, s[36:39], s75 offen sc1 lds
    s_add_u32 m0, s19, 143360
    s_add_u32 s75, s18, 987264
    buffer_load_dwordx4 v129, s[36:39], s75 offen sc1 lds
    s_waitcnt vmcnt(0)
    ds_read_b32 v170, v253 offset:0
    ds_read_b32 v171, v253 offset:4096
    ds_read_b32 v254, v253 offset:8192
    ds_read_b32 v251, v253 offset:12288
    s_waitcnt lgkmcnt(0)
    v_max3_u32 v170, v170, v171, v254
    v_max_u32 v170, v170, v251
    s_add_u32 s70, s70, 1
    s_cmp_gt_u32 s70, 200000
    s_cbranch_scc1 CNT8
    v_cmp_eq_u32 vcc, -1, v170
    s_cbranch_vccnz RTL8
    s_branch CNT8
RTY9:
    s_mov_b32 s70, 0
RTL9:
    s_sleep 2
    s_add_u32 m0, s19, 147456
    s_add_u32 s75, s18, 1314944
    buffer_load_dwordx4 v129, s[36:39], s75 offen sc1 lds
    s_add_u32 m0, s19, 151552
    s_add_u32 s75, s18, 1642624
    buffer_load_dwordx4 v129, s[36:39], s75 offen sc1 lds
    s_add_u32 m0, s19, 155648
    s_add_u32 s75, s18, 1970304
    buffer_load_dwordx4 v129, s[36:39], s75 offen sc1 lds
    s_add_u32 m0, s19, 159744
    s_add_u32 s75, s18, 2297984
    buffer_load_dwordx4 v129, s[36:39], s75 offen sc1 lds
    s_waitcnt vmcnt(0)
    ds_read_b32 v170, v253 offset:16384
    ds_read_b32 v171, v253 offset:20480
    ds_read_b32 v254, v253 offset:24576
    ds_read_b32 v251, v253 offset:28672
    s_waitcnt lgkmcnt(0)
    v_max3_u32 v170, v170, v171, v254
    v_max_u32 v170, v170, v251
    s_add_u32 s70, s70, 1
    s_cmp_gt_u32 s70, 200000
    s_cbranch_scc1 CNT9
    v_cmp_eq_u32 vcc, -1, v170
    s_cbranch_vccnz RTL9
    s_branch CNT9

.section .rodata,"a"
.p2align 6
.amdhsa_kernel sequential_preLN__ssm_conv_s4__glu_gated_reglu__prompt_kernel
  .amdhsa_next_free_vgpr 512
  .amdhsa_next_free_sgpr 80
  .amdhsa_accum_offset 256
  .amdhsa_group_segment_fixed_size 0
  .amdhsa_kernarg_size 128
  .amdhsa_user_sgpr_count 2
  .amdhsa_user_sgpr_kernarg_segment_ptr 1
  .amdhsa_system_sgpr_workgroup_id_x 1
.end_amdhsa_kernel
```
